```python
import torch

def _softmax(x, axis=-1):
    return torch.softmax(x, dim=axis)

def _gelu(x):
    return torch.nn.functional.gelu(x, approximate='tanh')

def _silu(x):
    return torch.nn.functional.silu(x)

def _sigmoid(x):
    return torch.sigmoid(x)

def _layernorm(x, axis=-1, eps=1e-05):
    m = x.mean(dim=axis, keepdim=True)
    v = x.var(dim=axis, keepdim=True, unbiased=False)
    return (x - m) / torch.sqrt(v + eps)

def _scatter_add(tgt, idx, src, axis=0):
    return tgt.clone().index_add_(axis, idx, src)

def _segment_sum(src, seg, n):
    out = torch.zeros((n,) + src.shape[1:], dtype=src.dtype)
    return out.index_add_(0, seg, src)

def _pad(x, pw):
    flat = tuple((v for pair in reversed(pw) for v in pair))
    return torch.nn.functional.pad(x, flat)
kernel_name = 'adaLN_cond__compressed_kv_cla__geglu_ffn__decode'

def setup_inputs():

    _w = lambda a: (lambda t: t.to(torch.bfloat16) if t.is_floating_point() else t)(torch.as_tensor(a))

    def _A_setup():
        B, H, Sq, Sk, D, M = (1, 32, 1, 16384, 128, 576)
        Dc = 4 * D
        return {'x': _w((lambda *s: torch.randn(*s, dtype=torch.bfloat16) * 0.05)(B, Sq, M)), 'c_kv': _w((lambda *s: torch.randn(*s, dtype=torch.bfloat16) * 1.6)(B, Sk, Dc)), 'w_q': _w((lambda *s: torch.randn(*s, dtype=torch.bfloat16) * 0.8)(M, H, D) * M ** (-0.5)), 'w_uk': _w((lambda *s: torch.randn(*s, dtype=torch.bfloat16) * 0.8)(Dc, H, D) * Dc ** (-0.5)), 'w_uv': _w((lambda *s: torch.randn(*s, dtype=torch.bfloat16) * 1.6)(Dc, H, D) * Dc ** (-0.5)), 'w_o': _w((lambda *s: torch.randn(*s, dtype=torch.bfloat16) * 1.6)(H, D, M) * (H * D) ** (-0.5))}
    _A_in = _A_setup()

    def _B_setup():
        B, S, D, F = (1, 1, 576, 4608)
        return {'x': _w((lambda *s: torch.randn(*s, dtype=torch.bfloat16) * 0.05)(B, S, D)), 'w_gate': _w((lambda *s: torch.randn(*s, dtype=torch.bfloat16) * 0.05)(D, F)), 'w_up': _w((lambda *s: torch.randn(*s, dtype=torch.bfloat16) * 0.05)(D, F)), 'w_down': _w((lambda *s: torch.randn(*s, dtype=torch.bfloat16) * 0.05)(F, D))}
    _B_in = _B_setup()
    return {'A_x': _A_in['x'], 'A_c_kv': _A_in['c_kv'], 'A_w_q': _A_in['w_q'], 'A_w_uk': _A_in['w_uk'], 'A_w_uv': _A_in['w_uv'], 'A_w_o': _A_in['w_o'], 'B_x': _B_in['x'], 'B_w_gate': _B_in['w_gate'], 'B_w_up': _B_in['w_up'], 'B_w_down': _B_in['w_down'], 'c': _w((lambda *s: torch.randn(*s, dtype=torch.bfloat16) * 0.1)(1, 576) * 8.0), 'w_mod': _w((lambda *s: torch.randn(*s, dtype=torch.bfloat16) * 0.1)(576, 6 * 576) * 576 ** (-0.5) * 8.0)}

def reference(A_x, A_c_kv, A_w_q, A_w_uk, A_w_uv, A_w_o, B_x, B_w_gate, B_w_up, B_w_down, c, w_mod):

    def _A_ref(x, c_kv, w_q, w_uk, w_uv, w_o):
        B, Sq, M = (x.shape[0], x.shape[1], x.shape[2])
        Sk = c_kv.shape[1]
        H, D = (w_q.shape[1], w_q.shape[2])
        q = torch.einsum('bqm,mhd->bhqd', x, w_q)
        k = torch.einsum('bkc,chd->bhkd', c_kv, w_uk)
        v = torch.einsum('bkc,chd->bhkd', c_kv, w_uv)
        scores = torch.einsum('bhqd,bhkd->bhqk', q, k) * D ** (-0.5)
        off = Sk - Sq
        qi = torch.arange(Sq)[:, None]
        kj = torch.arange(Sk)[None, :]
        cmask = kj <= qi + off
        scores = torch.where(cmask[None, None], scores, -1000000000.0)
        p = _softmax(scores, axis=-1)
        ctx = torch.einsum('bhqk,bhkd->bhqd', p, v)
        return torch.einsum('bhqd,hdm->bqm', ctx, w_o)

    def _B_ref(x, w_gate, w_up, w_down):
        return _gelu(x @ w_gate) * (x @ w_up) @ w_down
    x = A_x
    mod = (_silu(c) @ w_mod).reshape(c.shape[0], 6, 1, -1)
    sa, ca, ga, sb, cb, gb = (mod[:, 0].clone(), mod[:, 1].clone(), mod[:, 2].clone(), mod[:, 3].clone(), mod[:, 4].clone(), mod[:, 5].clone())
    h = _layernorm(x, axis=-1) * (1 + ca) + sa
    x = x + ga * _A_ref(h, A_c_kv, A_w_q, A_w_uk, A_w_uv, A_w_o)
    h = _layernorm(x, axis=-1) * (1 + cb) + sb
    x = x + gb * _B_ref(h, B_w_gate, B_w_up, B_w_down)
    return x
```

```asm
; @launch grid=(256,1,1) block=(256,1,1) lds=163840
.amdgcn_target "amdgcn-amd-amdhsa--gfx950"
.text
.globl adaLN_cond__compressed_kv_cla__geglu_ffn__decode_kernel
.p2align 8
.type adaLN_cond__compressed_kv_cla__geglu_ffn__decode_kernel,@function
adaLN_cond__compressed_kv_cla__geglu_ffn__decode_kernel:
    s_cmp_ge_u32 s2, 256
    s_cbranch_scc1 L_end
    s_load_dwordx16 s[4:19], s[0:1], 0
    s_load_dwordx8 s[20:27], s[0:1], 64
    s_load_dwordx4 s[28:31], s[0:1], 96
    s_load_dwordx2 s[32:33], s[0:1], 112
    v_lshrrev_b32 v8, 6, v0
    v_and_b32 v1, 63, v0
    v_readfirstlane_b32 s35, v8
    v_lshrrev_b32 v2, 4, v1
    v_and_b32 v3, 15, v1
    v_lshlrev_b32 v4, 4, v1
    s_mov_b32 s96, 0
    s_and_b32 s36, s2, 7
    s_lshr_b32 s37, s2, 4
    s_bitcmp0_b32 s2, 3
    s_cbranch_scc1 L_Y
    v_lshrrev_b32 v10, 3, v1
    v_and_b32 v9, 6, v10
    v_xor_b32 v9, v9, v1
    v_and_b32 v9, 7, v9
    v_lshlrev_b32 v9, 4, v9
    v_lshrrev_b32 v11, 2, v10
    v_and_b32 v10, 3, v10
    v_mov_b32 v12, 55296
    v_mad_u32_u24 v9, v11, v12, v9
    v_mov_b32 v12, 6912
    v_mad_u32_u24 v9, v10, v12, v9
    s_lshl4_add_u32 s97, s36, s37
    s_lshl2_add_u32 s46, s37, s36
    s_cmp_ge_u32 s36, 4
    s_cselect_b32 s46, 99, s46
    s_mul_i32 s73, s46, 3641
    s_lshr_b32 s73, s73, 16
    s_mul_i32 s74, s73, 18
    s_sub_u32 s74, s46, s74
    v_lshlrev_b32 v8, 2, v0
    s_and_b32 s70, s35, 1
    s_lshl_b32 s70, s70, 4
    s_and_b32 s71, s35, 2
    s_lshl_b32 s71, s71, 1
    s_add_u32 s70, s70, s71
    s_mul_i32 s71, s73, 192
    s_add_u32 s70, s70, s71
    s_mul_i32 s70, s70, 6912
    s_lshl_b32 s72, s74, 7
    s_add_u32 s70, s70, s72
    s_lshl_b32 s71, s71, 1
    s_lshl_b32 s72, s35, 10
    s_add_u32 m0, s72, 131072
    s_lshl_b32 s68, s97, 17
    s_lshl_b32 s69, s35, 15
    s_add_u32 s68, s68, s69
    v_xor_b32 v32, 0, v4
    v_xor_b32 v33, 32, v4
    v_xor_b32 v34, 64, v4
    v_xor_b32 v35, 96, v4
    v_xor_b32 v36, 128, v4
    v_xor_b32 v37, 160, v4
    v_xor_b32 v38, 192, v4
    v_xor_b32 v39, 224, v4
    v_xor_b32 v40, 144, v4
    v_xor_b32 v41, 176, v4
    v_xor_b32 v42, 208, v4
    v_xor_b32 v43, 240, v4
    v_xor_b32 v44, 16, v4
    v_xor_b32 v45, 48, v4
    v_xor_b32 v46, 80, v4
    v_xor_b32 v47, 112, v4
    s_waitcnt lgkmcnt(0)
    s_load_dword s34, s[32:33], 0
    s_cmp_ge_u32 s46, 54
    s_cbranch_scc1 L_noA
    s_mov_b64 s[64:65], s[26:27]
    s_mov_b32 s66, 3981312
    s_mov_b32 s67, 0x20000
    s_mov_b64 s[60:61], s[24:25]
    s_mov_b32 s62, 1152
    s_mov_b32 s63, 0x20000
    buffer_load_dword v28, v8, s[60:63], s71 offen
    buffer_load_dwordx4 v9, s[64:67], s70 offen nt lds
    s_add_u32 s70, s70, 221184
    s_add_u32 m0, m0, 4096
    s_nop 0
    buffer_load_dwordx4 v9, s[64:67], s70 offen nt lds
    s_add_u32 s70, s70, 221184
    s_add_u32 m0, m0, 4096
    s_nop 0
    buffer_load_dwordx4 v9, s[64:67], s70 offen nt lds
    s_add_u32 s70, s70, 221184
    s_add_u32 m0, m0, 4096
    s_nop 0
    buffer_load_dwordx4 v9, s[64:67], s70 offen nt lds
    s_add_u32 s70, s70, 221184
    s_add_u32 m0, m0, 4096
    s_nop 0
    buffer_load_dwordx4 v9, s[64:67], s70 offen nt lds
    s_add_u32 s70, s70, 221184
    s_add_u32 m0, m0, 4096
    s_nop 0
    buffer_load_dwordx4 v9, s[64:67], s70 offen nt lds
L_noA:
    s_mov_b64 s[52:53], s[6:7]
    s_mov_b32 s54, 16777216
    s_mov_b32 s55, 0x20000
    s_getpc_b64 s[56:57]
L_pc:
    s_sub_u32 s56, s56, L_pc-adaLN_cond__compressed_kv_cla__geglu_ffn__decode_kernel
    s_subb_u32 s57, s57, 0
    s_mov_b32 s58, 22692
    s_mov_b32 s59, 0x20000
    s_lshl2_add_u32 s70, s37, s35
    s_lshl_b32 s70, s70, 10
    s_mov_b32 m0, s69
    buffer_load_dwordx4 v[240:243], v4, s[56:59], s70 offen
    buffer_load_dwordx4 v32, s[52:55], s68 offen nt lds
    s_cmp_ge_u32 s46, 54
    s_cbranch_scc1 L_noA2
    s_mul_i32 s98, s73, 4608
    s_lshl2_add_u32 s74, s74, s35
    s_lshl_b32 s74, s74, 6
    s_add_u32 s98, s98, s74
    s_add_u32 s98, s98, 4096
    v_lshrrev_b32 v22, 2, v1
    v_lshlrev_b32 v20, 7, v22
    v_lshrrev_b32 v22, 1, v22
    v_and_b32 v22, 3, v22
    v_xor_b32 v22, s35, v22
    v_lshl_add_u32 v20, v22, 5, v20
    v_and_b32 v22, 3, v1
    v_lshl_add_u32 v20, v22, 3, v20
    v_add_u32 v20, 131072, v20
    v_mov_b32 v5, 0xfffefffe
    v_mov_b32 v6, 0xffffff00
    v_and_b32 v7, 6, v1
    s_waitcnt lgkmcnt(0)
    s_add_u32 s34, s34, 1
    s_and_b32 s39, s34, 0xff
    s_mul_i32 s43, s39, 0x8001
    v_lshrrev_b32 v7, v7, s43
    v_and_b32 v7, 0x10001, v7
    s_and_b32 s40, s43, 0x10001
    s_lshr_b32 s41, s43, 2
    s_and_b32 s41, s41, 0x10001
    s_lshr_b32 s42, s43, 4
    s_and_b32 s42, s42, 0x10001
    s_lshr_b32 s43, s43, 6
    s_and_b32 s43, s43, 0x10001
    s_mov_b64 s[48:49], s[32:33]
    s_mov_b32 s50, 6815744
    s_mov_b32 s51, 0x20000
    v_lshlrev_b32 v21, 4, v2
    v_add_u32 v22, 155648, v21
    v_add_u32 v8, 155648, v8
    s_waitcnt vmcnt(8)
    v_lshlrev_b32 v24, 16, v28
    v_and_b32 v25, 0xffff0000, v28
    v_mul_f32 v26, 0xbfb8aa3b, v24
    v_mul_f32 v27, 0xbfb8aa3b, v25
    v_exp_f32 v26, v26
    v_exp_f32 v27, v27
    v_add_f32 v26, 1.0, v26
    v_add_f32 v27, 1.0, v27
    v_rcp_f32 v26, v26
    v_rcp_f32 v27, v27
    v_mul_f32 v24, v24, v26
    v_mul_f32 v25, v25, v27
    v_cvt_pk_bf16_f32 v28, v24, v25
    ds_write_b32 v8, v28
    s_waitcnt vmcnt(2) lgkmcnt(0)
    s_barrier
    ds_read_b64_tr_b16 v[64:65], v20 offset:0
    ds_read_b64_tr_b16 v[66:67], v20 offset:2048
    ds_read_b128 v[88:91], v22 offset:0
    ds_read_b64_tr_b16 v[68:69], v20 offset:4096
    ds_read_b64_tr_b16 v[70:71], v20 offset:6144
    ds_read_b128 v[92:95], v22 offset:64
    ds_read_b64_tr_b16 v[72:73], v20 offset:8192
    ds_read_b64_tr_b16 v[74:75], v20 offset:10240
    ds_read_b128 v[96:99], v22 offset:128
    ds_read_b64_tr_b16 v[76:77], v20 offset:12288
    ds_read_b64_tr_b16 v[78:79], v20 offset:14336
    ds_read_b128 v[100:103], v22 offset:192
    ds_read_b64_tr_b16 v[80:81], v20 offset:16384
    ds_read_b64_tr_b16 v[82:83], v20 offset:18432
    ds_read_b128 v[104:107], v22 offset:256
    ds_read_b64_tr_b16 v[84:85], v20 offset:20480
    ds_read_b64_tr_b16 v[86:87], v20 offset:22528
    ds_read_b128 v[108:111], v22 offset:320
    s_waitcnt lgkmcnt(15)
    v_mfma_f32_16x16x32_bf16 v[24:27], v[64:67], v[88:91], 0
    s_waitcnt lgkmcnt(12)
    v_mfma_f32_16x16x32_bf16 v[24:27], v[68:71], v[92:95], v[24:27]
    s_waitcnt lgkmcnt(9)
    v_mfma_f32_16x16x32_bf16 v[24:27], v[72:75], v[96:99], v[24:27]
    s_waitcnt lgkmcnt(6)
    v_mfma_f32_16x16x32_bf16 v[24:27], v[76:79], v[100:103], v[24:27]
    s_waitcnt lgkmcnt(3)
    v_mfma_f32_16x16x32_bf16 v[24:27], v[80:83], v[104:107], v[24:27]
    s_waitcnt lgkmcnt(0)
    v_mfma_f32_16x16x32_bf16 v[24:27], v[84:87], v[108:111], v[24:27]
    s_nop 7
    v_and_or_b32 v24, v24, v6, s39
    v_and_or_b32 v25, v25, v6, s39
    v_and_or_b32 v26, v26, v6, s39
    v_and_or_b32 v27, v27, v6, s39
    s_mov_b32 exec_lo, 0x10001
    s_mov_b32 exec_hi, 0x10001
    buffer_store_dwordx4 v[24:27], v21, s[48:51], s98 offen sc1
    s_mov_b64 exec, -1
    buffer_load_dwordx4 v33, s[52:55], s68 offen offset:1024 nt lds
    buffer_load_dwordx4 v34, s[52:55], s68 offen offset:2048 nt lds
    buffer_load_dwordx4 v35, s[52:55], s68 offen offset:3072 nt lds
    s_add_u32 s68, s68, 4096
    s_add_u32 m0, m0, 4096
    s_nop 0
    buffer_load_dwordx4 v36, s[52:55], s68 offen nt lds
    buffer_load_dwordx4 v37, s[52:55], s68 offen offset:1024 nt lds
    buffer_load_dwordx4 v38, s[52:55], s68 offen offset:2048 nt lds
    buffer_load_dwordx4 v39, s[52:55], s68 offen offset:3072 nt lds
    s_add_u32 s68, s68, 4096
    s_add_u32 m0, m0, 4096
    s_nop 0
    buffer_load_dwordx4 v40, s[52:55], s68 offen nt lds
    buffer_load_dwordx4 v41, s[52:55], s68 offen offset:1024 nt lds
    buffer_load_dwordx4 v42, s[52:55], s68 offen offset:2048 nt lds
    buffer_load_dwordx4 v43, s[52:55], s68 offen offset:3072 nt lds
    s_branch L_hj
L_noA2:
    buffer_load_dwordx4 v33, s[52:55], s68 offen offset:1024 nt lds
    buffer_load_dwordx4 v34, s[52:55], s68 offen offset:2048 nt lds
    buffer_load_dwordx4 v35, s[52:55], s68 offen offset:3072 nt lds
    s_add_u32 s68, s68, 4096
    s_add_u32 m0, m0, 4096
    s_waitcnt vmcnt(3)
    buffer_load_dwordx4 v36, s[52:55], s68 offen nt lds
    s_waitcnt vmcnt(3)
    buffer_load_dwordx4 v37, s[52:55], s68 offen offset:1024 nt lds
    s_waitcnt vmcnt(3)
    buffer_load_dwordx4 v38, s[52:55], s68 offen offset:2048 nt lds
    s_waitcnt vmcnt(3)
    buffer_load_dwordx4 v39, s[52:55], s68 offen offset:3072 nt lds
    s_add_u32 s68, s68, 4096
    s_add_u32 m0, m0, 4096
    s_waitcnt vmcnt(3)
    buffer_load_dwordx4 v40, s[52:55], s68 offen nt lds
    s_waitcnt vmcnt(3)
    buffer_load_dwordx4 v41, s[52:55], s68 offen offset:1024 nt lds
    s_waitcnt vmcnt(3)
    buffer_load_dwordx4 v42, s[52:55], s68 offen offset:2048 nt lds
    s_waitcnt vmcnt(3)
    buffer_load_dwordx4 v43, s[52:55], s68 offen offset:3072 nt lds
L_hj:
    s_add_u32 s68, s68, 4096
    s_add_u32 m0, m0, 4096
    s_nop 0
    buffer_load_dwordx4 v44, s[52:55], s68 offen nt lds
    buffer_load_dwordx4 v45, s[52:55], s68 offen offset:1024 nt lds
    buffer_load_dwordx4 v46, s[52:55], s68 offen offset:2048 nt lds
    buffer_load_dwordx4 v47, s[52:55], s68 offen offset:3072 nt lds
    s_add_u32 s68, s68, 4096
    s_add_u32 m0, m0, 4096
    s_nop 0
    buffer_load_dwordx4 v32, s[52:55], s68 offen nt lds
    buffer_load_dwordx4 v33, s[52:55], s68 offen offset:1024 nt lds
    buffer_load_dwordx4 v34, s[52:55], s68 offen offset:2048 nt lds
    buffer_load_dwordx4 v35, s[52:55], s68 offen offset:3072 nt lds
    s_add_u32 s68, s68, 4096
    s_add_u32 m0, m0, 4096
    s_nop 0
    buffer_load_dwordx4 v36, s[52:55], s68 offen nt lds
    buffer_load_dwordx4 v37, s[52:55], s68 offen offset:1024 nt lds
    buffer_load_dwordx4 v38, s[52:55], s68 offen offset:2048 nt lds
    buffer_load_dwordx4 v39, s[52:55], s68 offen offset:3072 nt lds
    s_add_u32 s68, s68, 4096
    s_add_u32 m0, m0, 4096
    s_nop 0
    buffer_load_dwordx4 v40, s[52:55], s68 offen nt lds
    buffer_load_dwordx4 v41, s[52:55], s68 offen offset:1024 nt lds
    buffer_load_dwordx4 v42, s[52:55], s68 offen offset:2048 nt lds
    buffer_load_dwordx4 v43, s[52:55], s68 offen offset:3072 nt lds
    s_add_u32 s68, s68, 4096
    s_add_u32 m0, m0, 4096
    s_nop 0
    buffer_load_dwordx4 v44, s[52:55], s68 offen nt lds
    buffer_load_dwordx4 v45, s[52:55], s68 offen offset:1024 nt lds
    buffer_load_dwordx4 v46, s[52:55], s68 offen offset:2048 nt lds
    buffer_load_dwordx4 v47, s[52:55], s68 offen offset:3072 nt lds
    s_cmp_lt_u32 s46, 54
    s_cbranch_scc1 L_tg
    v_mov_b32 v5, 0xfffefffe
    v_mov_b32 v6, 0xffffff00
    v_and_b32 v7, 6, v1
    s_waitcnt lgkmcnt(0)
    s_add_u32 s34, s34, 1
    s_and_b32 s39, s34, 0xff
    s_mul_i32 s43, s39, 0x8001
    v_lshrrev_b32 v7, v7, s43
    v_and_b32 v7, 0x10001, v7
    s_and_b32 s40, s43, 0x10001
    s_lshr_b32 s41, s43, 2
    s_and_b32 s41, s41, 0x10001
    s_lshr_b32 s42, s43, 4
    s_and_b32 s42, s42, 0x10001
    s_lshr_b32 s43, s43, 6
    s_and_b32 s43, s43, 0x10001
    s_mov_b64 s[48:49], s[32:33]
    s_mov_b32 s50, 6815744
    s_mov_b32 s51, 0x20000
L_tg:
    v_mov_b32 v244, 0
    v_mov_b32 v246, 0
    s_lshr_b32 s98, s37, 2
    s_lshl2_add_u32 s44, s36, s98
    s_and_b32 s45, s37, 3
    s_lshl2_add_u32 s98, s36, s35
    s_lshl4_add_u32 s98, s98, s37
    s_lshl_b32 s98, s98, 6
    s_mov_b64 s[64:65], s[12:13]
    s_mov_b32 s66, 4194304
    s_mov_b32 s67, 0x20000
    s_mov_b64 s[52:53], s[14:15]
    s_mov_b32 s54, 4718592
    s_mov_b32 s55, 0x20000
    s_mov_b64 s[60:61], s[4:5]
    s_mov_b32 s62, 1152
    s_mov_b32 s63, 0x20000
    v_lshrrev_b32 v9, 3, v3
    v_mul_u32_u24 v9, 9, v9
    v_lshlrev_b32 v8, 1, v3
    v_and_b32 v8, 14, v8
    v_xor_b32 v8, v8, v9
    v_xor_b32 v8, v8, v2
    v_lshlrev_b32 v8, 4, v8
    v_lshl_add_u32 v8, v3, 10, v8
    s_mul_i32 s70, s35, 33024
    v_add_u32 v12, s70, v8
    v_lshrrev_b32 v10, 2, v1
    v_xor_b32 v32, 0, v12
    v_xor_b32 v33, 64, v12
    v_xor_b32 v34, 128, v12
    v_xor_b32 v35, 192, v12
    v_xor_b32 v36, 256, v12
    v_xor_b32 v37, 320, v12
    v_xor_b32 v38, 384, v12
    v_xor_b32 v39, 448, v12
    v_xor_b32 v40, 512, v12
    v_xor_b32 v41, 576, v12
    v_xor_b32 v42, 640, v12
    v_xor_b32 v43, 704, v12
    v_xor_b32 v44, 768, v12
    v_xor_b32 v45, 832, v12
    v_xor_b32 v46, 896, v12
    v_xor_b32 v47, 960, v12
    v_lshrrev_b32 v9, 3, v10
    v_mul_u32_u24 v9, 9, v9
    v_lshlrev_b32 v8, 1, v10
    v_and_b32 v8, 14, v8
    v_xor_b32 v8, v8, v9
    v_bfe_u32 v9, v1, 1, 1
    v_xor_b32 v8, v8, v9
    v_lshlrev_b32 v8, 4, v8
    v_lshl_add_u32 v8, v10, 10, v8
    v_and_b32 v9, 1, v1
    v_lshl_add_u32 v8, v9, 3, v8
    s_lshl_b32 s70, s35, 8
    v_add_u32 v48, s70, v8
    v_xor_b32 v49, 32, v48
    v_xor_b32 v50, 64, v48
    v_xor_b32 v51, 96, v48
    v_xor_b32 v52, 128, v48
    v_xor_b32 v53, 160, v48
    v_xor_b32 v54, 192, v48
    v_xor_b32 v55, 224, v48
    v_add_u32 v56, 0x10000, v48
    v_add_u32 v57, 0x10000, v49
    v_add_u32 v58, 0x10000, v50
    v_add_u32 v59, 0x10000, v51
    v_add_u32 v60, 0x10000, v52
    v_add_u32 v61, 0x10000, v53
    v_add_u32 v62, 0x10000, v54
    v_add_u32 v63, 0x10000, v55
    v_lshlrev_b32 v8, 1, v2
    v_xor_b32 v247, v8, v3
    v_lshlrev_b32 v247, 4, v247
    v_mov_b32 v8, 8192
    v_mad_u32_u24 v247, v2, v8, v247
    v_lshrrev_b32 v13, 2, v3
    v_lshlrev_b32 v13, 8, v13
    v_lshl_add_u32 v13, v2, 6, v13
    v_and_b32 v9, 3, v1
    v_lshl_add_u32 v13, v9, 4, v13
    s_lshl_b32 s70, s35, 13
    s_add_u32 s72, s70, 65536
    s_add_u32 s73, s70, 69632
    s_add_u32 s70, s70, 98304
    v_add_u32 v14, s70, v4
    v_xor_b32 v15, 0x2000, v14
    v_xor_b32 v16, 0x4000, v14
    v_xor_b32 v17, 0x6000, v14
    v_add_u32 v19, 73728, v4
    s_lshl_b32 s70, s35, 10
    v_add_u32 v18, s70, v19
    v_lshlrev_b32 v20, 4, v3
    v_add_u32 v20, 81920, v20
    s_lshl_b32 s70, s35, 2
    v_add_u32 v12, s70, v20
    v_lshlrev_b32 v21, 4, v3
    v_lshl_add_u32 v21, v2, 19, v21
    v_lshlrev_b32 v22, 10, v3
    s_lshl_b32 s74, s35, 15
    s_lshl_b32 s70, s97, 8
    s_add_u32 s74, s74, s70
    s_add_u32 s74, s74, 1048576
    s_add_u32 s47, s74, 2097152
    s_and_b32 s75, s97, 64
    s_lshl_b32 s75, s75, 3
    s_and_b32 s70, s97, 3
    s_lshl_b32 s70, s70, 7
    s_add_u32 s75, s75, s70
    s_and_b32 s70, s97, 0x3c
    s_lshl1_add_u32 s75, s70, s75
    s_lshl_b32 s70, s35, 14
    s_add_u32 s75, s75, s70
    s_add_u32 s75, s75, 98304
    s_and_b32 s46, s34, 0xffff
    s_and_b32 s70, s74, 0x300
    s_andn2_b32 s74, s74, 0x300
    s_xor_b32 s47, s74, 2101248
    v_lshlrev_b32 v9, 8, v2
    v_xor_b32 v9, s70, v9
    v_add_u32 v21, v21, v9
    s_and_b32 s70, s75, 0x3ff
    s_andn2_b32 s75, s75, 0x3ff
    s_lshl_b32 s71, s35, 5
    s_xor_b32 s70, s70, s71
    v_lshrrev_b32 v9, 2, v3
    v_lshlrev_b32 v9, 7, v9
    v_and_b32 v10, 3, v3
    v_lshl_add_u32 v9, v10, 3, v9
    v_xor_b32 v9, s70, v9
    v_add_u32 v22, v22, v9
    s_mov_b32 s38, 0x3e0293ee
    v_mov_b32 v24, 0x3f803f80
    v_mov_b32 v25, v24
    v_mov_b32 v26, v24
    v_mov_b32 v27, v24
    s_lshl_b32 s24, s45, 20
    s_lshl_b32 s69, s35, 18
    s_add_u32 s24, s24, s69
    s_lshl_b32 s69, s44, 8
    s_add_u32 s24, s24, s69
    s_lshl_b32 s25, s35, 13
    s_add_u32 s25, s25, 131072
    s_cmp_lt_u32 s37, 14
    s_cbranch_scc1 L_nfs
    s_sub_u32 s68, 3, s36
    s_and_b32 s68, s68, 7
    s_add_u32 s68, s68, 4
    s_sub_u32 s97, s68, 9
    s_cmp_ge_u32 s68, 9
    s_cselect_b32 s68, s97, s68
    s_mul_i32 s97, s36, 9
    s_add_u32 s97, s97, s68
    s_and_b32 s68, s37, 1
    s_lshl1_add_u32 s97, s97, s68
    s_mov_b64 s[52:53], s[18:19]
    s_mov_b32 s54, 5308416
    s_mov_b32 s55, 0x20000
    s_mov_b64 s[56:57], s[20:21]
    s_mov_b32 s58, 5308416
    s_mov_b32 s59, 0x20000
    s_mov_b64 s[60:61], s[22:23]
    s_mov_b32 s62, 5308416
    s_mov_b32 s63, 0x20000
    v_lshrrev_b32 v8, 3, v1
    v_and_b32 v244, 6, v8
    v_xor_b32 v244, v244, v1
    v_and_b32 v244, 7, v244
    v_lshlrev_b32 v244, 4, v244
    v_lshrrev_b32 v9, 2, v8
    v_and_b32 v8, 3, v8
    v_mov_b32 v10, 73728
    v_mad_u32_u24 v244, v9, v10, v244
    v_mov_b32 v10, 9216
    v_mad_u32_u24 v244, v8, v10, v244
    v_lshrrev_b32 v8, 3, v1
    v_and_b32 v246, 6, v8
    v_xor_b32 v246, v246, v1
    v_and_b32 v246, 7, v246
    v_lshlrev_b32 v246, 4, v246
    v_lshrrev_b32 v9, 2, v8
    v_and_b32 v8, 3, v8
    v_mov_b32 v10, 9216
    v_mad_u32_u24 v246, v9, v10, v246
    v_mov_b32 v10, 1152
    v_mad_u32_u24 v246, v8, v10, v246
    s_and_b32 s99, s35, 1
    s_lshl_b32 s99, s99, 4
    s_and_b32 s68, s35, 2
    s_lshl_b32 s68, s68, 1
    s_add_u32 s99, s99, s68
    s_and_b32 s30, s97, 1
    s_mul_i32 s68, s30, 288
    s_add_u32 s99, s99, s68
    s_mul_i32 s99, s99, 9216
    s_lshr_b32 s68, s97, 1
    s_lshl_b32 s68, s68, 7
    s_add_u32 s99, s99, s68
    s_lshl_b32 s3, s35, 10
L_nfs:
    s_waitcnt vmcnt(16)
    s_barrier
    s_mov_b32 m0, s25
    s_nop 0
    buffer_load_dwordx4 v247, s[64:67], s24 offen nt lds
    s_add_u32 s24, s24, 32768
    s_add_u32 m0, m0, 1024
    s_nop 0
    buffer_load_dwordx4 v247, s[64:67], s24 offen nt lds
    s_add_u32 s24, s24, 32768
    s_add_u32 m0, m0, 1024
    s_nop 0
    buffer_load_dwordx4 v247, s[64:67], s24 offen nt lds
    s_add_u32 s24, s24, 32768
    s_add_u32 m0, m0, 1024
    s_nop 0
    buffer_load_dwordx4 v247, s[64:67], s24 offen nt lds
    s_add_u32 s24, s24, 32768
    s_add_u32 m0, m0, 1024
    s_nop 0
    buffer_load_dwordx4 v247, s[64:67], s24 offen nt lds
    s_add_u32 s24, s24, 32768
    s_add_u32 m0, m0, 1024
    s_nop 0
    buffer_load_dwordx4 v247, s[64:67], s24 offen nt lds
    s_add_u32 s24, s24, 32768
    s_add_u32 m0, m0, 1024
    s_nop 0
    buffer_load_dwordx4 v247, s[64:67], s24 offen nt lds
    s_add_u32 s24, s24, 32768
    s_add_u32 m0, m0, 1024
    s_nop 0
    buffer_load_dwordx4 v247, s[64:67], s24 offen nt lds
    ds_read_b128 a[0:3], v32 offset:0
    ds_read_b128 a[4:7], v33 offset:0
    ds_read_b128 a[8:11], v34 offset:0
    ds_read_b128 a[12:15], v35 offset:0
    ds_read_b128 a[16:19], v36 offset:0
    ds_read_b128 a[20:23], v37 offset:0
    ds_read_b128 a[24:27], v38 offset:0
    ds_read_b128 a[28:31], v39 offset:0
    ds_read_b128 a[32:35], v40 offset:0
    ds_read_b128 a[36:39], v41 offset:0
    ds_read_b128 a[40:43], v42 offset:0
    ds_read_b128 a[44:47], v43 offset:0
    ds_read_b128 a[48:51], v44 offset:0
    ds_read_b128 a[52:55], v45 offset:0
    ds_read_b128 a[56:59], v46 offset:0
    ds_read_b128 a[60:63], v47 offset:0
    ds_read_b64_tr_b16 a[128:129], v48 offset:0
    ds_read_b64_tr_b16 a[144:145], v49 offset:0
    ds_read_b64_tr_b16 a[160:161], v50 offset:0
    ds_read_b64_tr_b16 a[176:177], v51 offset:0
    ds_read_b64_tr_b16 a[192:193], v52 offset:0
    ds_read_b64_tr_b16 a[208:209], v53 offset:0
    ds_read_b64_tr_b16 a[224:225], v54 offset:0
    ds_read_b64_tr_b16 a[240:241], v55 offset:0
    ds_read_b64_tr_b16 a[132:133], v48 offset:32768
    ds_read_b64_tr_b16 a[148:149], v49 offset:32768
    ds_read_b64_tr_b16 a[164:165], v50 offset:32768
    ds_read_b64_tr_b16 a[180:181], v51 offset:32768
    ds_read_b64_tr_b16 a[196:197], v52 offset:32768
    ds_read_b64_tr_b16 a[212:213], v53 offset:32768
    ds_read_b64_tr_b16 a[228:229], v54 offset:32768
    ds_read_b64_tr_b16 a[244:245], v55 offset:32768
    ds_read_b64_tr_b16 a[136:137], v56 offset:0
    ds_read_b64_tr_b16 a[152:153], v57 offset:0
    ds_read_b64_tr_b16 a[168:169], v58 offset:0
    ds_read_b64_tr_b16 a[184:185], v59 offset:0
    ds_read_b64_tr_b16 a[200:201], v60 offset:0
    ds_read_b64_tr_b16 a[216:217], v61 offset:0
    ds_read_b64_tr_b16 a[232:233], v62 offset:0
    ds_read_b64_tr_b16 a[248:249], v63 offset:0
    ds_read_b64_tr_b16 a[140:141], v56 offset:32768
    ds_read_b64_tr_b16 a[156:157], v57 offset:32768
    ds_read_b64_tr_b16 a[172:173], v58 offset:32768
    ds_read_b64_tr_b16 a[188:189], v59 offset:32768
    ds_read_b64_tr_b16 a[204:205], v60 offset:32768
    ds_read_b64_tr_b16 a[220:221], v61 offset:32768
    ds_read_b64_tr_b16 a[236:237], v62 offset:32768
    ds_read_b64_tr_b16 a[252:253], v63 offset:32768
    s_waitcnt vmcnt(8)
    s_barrier
    ds_read_b128 a[64:67], v32 offset:16384
    ds_read_b128 a[68:71], v33 offset:16384
    ds_read_b128 a[72:75], v34 offset:16384
    ds_read_b128 a[76:79], v35 offset:16384
    ds_read_b128 a[80:83], v36 offset:16384
    ds_read_b128 a[84:87], v37 offset:16384
    ds_read_b128 a[88:91], v38 offset:16384
    ds_read_b128 a[92:95], v39 offset:16384
    ds_read_b128 a[96:99], v40 offset:16384
    ds_read_b128 a[100:103], v41 offset:16384
    ds_read_b128 a[104:107], v42 offset:16384
    ds_read_b128 a[108:111], v43 offset:16384
    ds_read_b128 a[112:115], v44 offset:16384
    ds_read_b128 a[116:119], v45 offset:16384
    ds_read_b128 a[120:123], v46 offset:16384
    ds_read_b128 a[124:127], v47 offset:16384
    ds_read_b64_tr_b16 a[130:131], v48 offset:16384
    ds_read_b64_tr_b16 a[146:147], v49 offset:16384
    ds_read_b64_tr_b16 a[162:163], v50 offset:16384
    ds_read_b64_tr_b16 a[178:179], v51 offset:16384
    ds_read_b64_tr_b16 a[194:195], v52 offset:16384
    ds_read_b64_tr_b16 a[210:211], v53 offset:16384
    ds_read_b64_tr_b16 a[226:227], v54 offset:16384
    ds_read_b64_tr_b16 a[242:243], v55 offset:16384
    ds_read_b64_tr_b16 a[134:135], v48 offset:49152
    ds_read_b64_tr_b16 a[150:151], v49 offset:49152
    ds_read_b64_tr_b16 a[166:167], v50 offset:49152
    ds_read_b64_tr_b16 a[182:183], v51 offset:49152
    ds_read_b64_tr_b16 a[198:199], v52 offset:49152
    ds_read_b64_tr_b16 a[214:215], v53 offset:49152
    ds_read_b64_tr_b16 a[230:231], v54 offset:49152
    ds_read_b64_tr_b16 a[246:247], v55 offset:49152
    ds_read_b64_tr_b16 a[138:139], v56 offset:16384
    ds_read_b64_tr_b16 a[154:155], v57 offset:16384
    ds_read_b64_tr_b16 a[170:171], v58 offset:16384
    ds_read_b64_tr_b16 a[186:187], v59 offset:16384
    ds_read_b64_tr_b16 a[202:203], v60 offset:16384
    ds_read_b64_tr_b16 a[218:219], v61 offset:16384
    ds_read_b64_tr_b16 a[234:235], v62 offset:16384
    ds_read_b64_tr_b16 a[250:251], v63 offset:16384
    ds_read_b64_tr_b16 a[142:143], v56 offset:49152
    ds_read_b64_tr_b16 a[158:159], v57 offset:49152
    ds_read_b64_tr_b16 a[174:175], v58 offset:49152
    ds_read_b64_tr_b16 a[190:191], v59 offset:49152
    ds_read_b64_tr_b16 a[206:207], v60 offset:49152
    ds_read_b64_tr_b16 a[222:223], v61 offset:49152
    ds_read_b64_tr_b16 a[238:239], v62 offset:49152
    ds_read_b64_tr_b16 a[254:255], v63 offset:49152
    v_lshrrev_b32 v8, 3, v1
    v_and_b32 v23, 6, v8
    v_xor_b32 v23, v23, v1
    v_and_b32 v23, 7, v23
    v_lshlrev_b32 v23, 4, v23
    v_lshrrev_b32 v9, 2, v8
    v_and_b32 v8, 3, v8
    v_mov_b32 v10, 9216
    v_mad_u32_u24 v23, v9, v10, v23
    v_mov_b32 v10, 1152
    v_mad_u32_u24 v23, v8, v10, v23
    s_and_b32 s68, s35, 1
    s_lshl_b32 s68, s68, 4
    s_and_b32 s69, s35, 2
    s_lshl_b32 s69, s69, 1
    s_add_u32 s68, s68, s69
    s_lshl_b32 s69, s36, 9
    s_add_u32 s68, s68, s69
    s_mul_i32 s68, s68, 1152
    s_lshl_b32 s69, s37, 7
    s_add_u32 s68, s68, s69
    v_mov_b32 v10, 0xff800000
    v_mov_b32 v11, v10
    s_waitcnt lgkmcnt(0)
    s_barrier
    ds_write_b64 v20, v[10:11]
qa_1:
    buffer_load_dwordx4 v[64:67], v13, s[48:51], s72 offen sc1
    buffer_load_dwordx4 v[68:71], v13, s[48:51], s72 offen offset:1024 sc1
    buffer_load_dwordx4 v[72:75], v13, s[48:51], s72 offen offset:2048 sc1
    buffer_load_dwordx4 v[76:79], v13, s[48:51], s72 offen offset:3072 sc1
    buffer_load_dwordx4 v[80:83], v13, s[48:51], s73 offen sc1
    buffer_load_dwordx4 v[84:87], v13, s[48:51], s73 offen offset:1024 sc1
    buffer_load_dwordx4 v[88:91], v13, s[48:51], s73 offen offset:2048 sc1
    buffer_load_dwordx4 v[92:95], v13, s[48:51], s73 offen offset:3072 sc1
    s_mov_b64 exec, -1
    s_add_u32 s96, s96, 1
    s_cmp_ge_u32 s96, 40000
    s_cbranch_scc1 L_done
    s_waitcnt vmcnt(0)
L_qe:
    v_mfma_f32_16x16x32_bf16 v[192:195], a[0:3], v[64:67], 0
    ds_write_b128 v14, v[64:67] offset:0
    v_xor_b32 v28, s40, v64
    v_bitop3_b32 v28, v65, s41, v28 bitop3:0xbe
    v_bitop3_b32 v28, v66, s42, v28 bitop3:0xbe
    v_bitop3_b32 v28, v67, s43, v28 bitop3:0xbe
    v_mfma_f32_16x16x32_bf16 v[200:203], a[64:67], v[64:67], 0
    ds_write_b128 v14, v[72:75] offset:2048
    v_bitop3_b32 v28, v68, s40, v28 bitop3:0xbe
    v_bitop3_b32 v28, v69, s41, v28 bitop3:0xbe
    v_bitop3_b32 v28, v70, s42, v28 bitop3:0xbe
    v_bitop3_b32 v28, v71, s43, v28 bitop3:0xbe
    v_mfma_f32_16x16x32_bf16 v[192:195], a[4:7], v[72:75], v[192:195]
    ds_write_b128 v14, v[80:83] offset:4096
    v_bitop3_b32 v28, v72, s40, v28 bitop3:0xbe
    v_bitop3_b32 v28, v73, s41, v28 bitop3:0xbe
    v_bitop3_b32 v28, v74, s42, v28 bitop3:0xbe
    v_bitop3_b32 v28, v75, s43, v28 bitop3:0xbe
    v_mfma_f32_16x16x32_bf16 v[200:203], a[68:71], v[72:75], v[200:203]
    ds_write_b128 v14, v[88:91] offset:6144
    v_bitop3_b32 v28, v76, s40, v28 bitop3:0xbe
    v_bitop3_b32 v28, v77, s41, v28 bitop3:0xbe
    v_bitop3_b32 v28, v78, s42, v28 bitop3:0xbe
    v_bitop3_b32 v28, v79, s43, v28 bitop3:0xbe
    v_mfma_f32_16x16x32_bf16 v[192:195], a[8:11], v[80:83], v[192:195]
    ds_write_b128 v14, v[68:71] offset:1024
    v_bitop3_b32 v28, v80, s40, v28 bitop3:0xbe
    v_bitop3_b32 v28, v81, s41, v28 bitop3:0xbe
    v_bitop3_b32 v28, v82, s42, v28 bitop3:0xbe
    v_bitop3_b32 v28, v83, s43, v28 bitop3:0xbe
    v_mfma_f32_16x16x32_bf16 v[200:203], a[72:75], v[80:83], v[200:203]
    ds_write_b128 v14, v[76:79] offset:3072
    v_bitop3_b32 v28, v84, s40, v28 bitop3:0xbe
    v_bitop3_b32 v28, v85, s41, v28 bitop3:0xbe
    v_bitop3_b32 v28, v86, s42, v28 bitop3:0xbe
    v_bitop3_b32 v28, v87, s43, v28 bitop3:0xbe
    v_mfma_f32_16x16x32_bf16 v[192:195], a[12:15], v[88:91], v[192:195]
    ds_write_b128 v14, v[84:87] offset:5120
    v_bitop3_b32 v28, v88, s40, v28 bitop3:0xbe
    v_bitop3_b32 v28, v89, s41, v28 bitop3:0xbe
    v_bitop3_b32 v28, v90, s42, v28 bitop3:0xbe
    v_bitop3_b32 v28, v91, s43, v28 bitop3:0xbe
    v_mfma_f32_16x16x32_bf16 v[200:203], a[76:79], v[88:91], v[200:203]
    ds_write_b128 v14, v[92:95] offset:7168
    v_bitop3_b32 v28, v92, s40, v28 bitop3:0xbe
    v_bitop3_b32 v28, v93, s41, v28 bitop3:0xbe
    v_bitop3_b32 v28, v94, s42, v28 bitop3:0xbe
    v_bitop3_b32 v28, v95, s43, v28 bitop3:0xbe
    v_and_b32 v28, 0x10001, v28
    v_cmp_ne_u32 vcc, 0, v28
    s_wqm_b64 exec, vcc
    s_cbranch_execnz qa_1
    s_mov_b64 exec, -1
    s_cmp_ge_u32 s37, 9
    s_cbranch_scc1 L_dbn1
    s_lshl_b32 m0, s35, 10
    s_nop 0
    buffer_load_dwordx4 v23, s[52:55], s68 offen nt lds
    s_add_u32 s68, s68, 36864
    s_add_u32 m0, m0, 4096
    s_nop 0
    buffer_load_dwordx4 v23, s[52:55], s68 offen nt lds
    s_add_u32 s68, s68, 36864
    s_add_u32 m0, m0, 4096
    s_nop 0
    buffer_load_dwordx4 v23, s[52:55], s68 offen nt lds
    s_add_u32 s68, s68, 36864
    s_add_u32 m0, m0, 4096
    s_nop 0
    buffer_load_dwordx4 v23, s[52:55], s68 offen nt lds
    s_add_u32 s68, s68, 36864
    s_add_u32 m0, m0, 4096
    s_nop 0
    buffer_load_dwordx4 v23, s[52:55], s68 offen nt lds
    s_add_u32 s68, s68, 36864
    s_add_u32 m0, m0, 4096
    s_nop 0
    buffer_load_dwordx4 v23, s[52:55], s68 offen nt lds
    s_add_u32 s68, s68, 36864
    s_add_u32 m0, m0, 4096
    s_nop 0
    buffer_load_dwordx4 v23, s[52:55], s68 offen nt lds
    s_add_u32 s68, s68, 36864
    s_add_u32 m0, m0, 4096
    s_nop 0
    buffer_load_dwordx4 v23, s[52:55], s68 offen nt lds
    s_add_u32 s68, s68, 36864
L_dbn1:
    s_cmp_lt_u32 s37, 14
    s_cbranch_scc1 L_dbp1
    s_add_u32 m0, s3, 0
    s_add_u32 s68, s99, 0
    buffer_load_dwordx4 v244, s[52:55], s68 offen nt lds
    s_add_u32 m0, s3, 36864
    s_add_u32 s68, s99, 0
    buffer_load_dwordx4 v244, s[56:59], s68 offen nt lds
    s_add_u32 m0, s3, 4096
    s_add_u32 s68, s99, 294912
    buffer_load_dwordx4 v244, s[52:55], s68 offen nt lds
    s_add_u32 m0, s3, 40960
    s_add_u32 s68, s99, 294912
    buffer_load_dwordx4 v244, s[56:59], s68 offen nt lds
    s_add_u32 m0, s3, 8192
    s_add_u32 s68, s99, 589824
    buffer_load_dwordx4 v244, s[52:55], s68 offen nt lds
    s_add_u32 m0, s3, 45056
    s_add_u32 s68, s99, 589824
    buffer_load_dwordx4 v244, s[56:59], s68 offen nt lds
    s_add_u32 m0, s3, 12288
    s_add_u32 s68, s99, 884736
    buffer_load_dwordx4 v244, s[52:55], s68 offen nt lds
    s_add_u32 m0, s3, 49152
    s_add_u32 s68, s99, 884736
    buffer_load_dwordx4 v244, s[56:59], s68 offen nt lds
    s_add_u32 m0, s3, 16384
    s_add_u32 s68, s99, 1179648
    buffer_load_dwordx4 v244, s[52:55], s68 offen nt lds
    s_add_u32 m0, s3, 53248
    s_add_u32 s68, s99, 1179648
    buffer_load_dwordx4 v244, s[56:59], s68 offen nt lds
    s_add_u32 m0, s3, 20480
    s_add_u32 s68, s99, 1474560
    buffer_load_dwordx4 v244, s[52:55], s68 offen nt lds
    s_add_u32 m0, s3, 57344
    s_add_u32 s68, s99, 1474560
    buffer_load_dwordx4 v244, s[56:59], s68 offen nt lds
L_dbp1:
L_dbe1:
    s_waitcnt lgkmcnt(0)
    s_barrier
    ds_read_b128 v[96:99], v15 offset:0
    ds_read_b128 v[100:103], v15 offset:2048
    ds_read_b128 v[104:107], v15 offset:4096
    ds_read_b128 v[108:111], v15 offset:6144
    v_mfma_f32_16x16x32_bf16 v[196:199], a[0:3], v[68:71], 0
    ds_read_b128 v[112:115], v16 offset:0
    ds_read_b128 v[116:119], v16 offset:2048
    ds_read_b128 v[120:123], v16 offset:4096
    v_mfma_f32_16x16x32_bf16 v[204:207], a[64:67], v[68:71], 0
    ds_read_b128 v[124:127], v16 offset:6144
    ds_read_b128 v[128:131], v17 offset:0
    ds_read_b128 v[132:135], v17 offset:2048
    v_mfma_f32_16x16x32_bf16 v[196:199], a[4:7], v[76:79], v[196:199]
    ds_read_b128 v[136:139], v17 offset:4096
    ds_read_b128 v[140:143], v17 offset:6144
    v_mfma_f32_16x16x32_bf16 v[204:207], a[68:71], v[76:79], v[204:207]
    s_waitcnt lgkmcnt(11)
    v_mfma_f32_16x16x32_bf16 v[192:195], a[16:19], v[96:99], v[192:195]
    ds_read_b128 v[144:147], v15 offset:1024
    v_mfma_f32_16x16x32_bf16 v[200:203], a[80:83], v[96:99], v[200:203]
    s_waitcnt lgkmcnt(11)
    v_mfma_f32_16x16x32_bf16 v[192:195], a[20:23], v[100:103], v[192:195]
    ds_read_b128 v[148:151], v15 offset:3072
    v_mfma_f32_16x16x32_bf16 v[200:203], a[84:87], v[100:103], v[200:203]
    s_waitcnt lgkmcnt(11)
    v_mfma_f32_16x16x32_bf16 v[192:195], a[24:27], v[104:107], v[192:195]
    ds_read_b128 v[152:155], v15 offset:5120
    v_mfma_f32_16x16x32_bf16 v[200:203], a[88:91], v[104:107], v[200:203]
    s_waitcnt lgkmcnt(11)
    v_mfma_f32_16x16x32_bf16 v[192:195], a[28:31], v[108:111], v[192:195]
    ds_read_b128 v[156:159], v15 offset:7168
    v_mfma_f32_16x16x32_bf16 v[200:203], a[92:95], v[108:111], v[200:203]
    s_waitcnt lgkmcnt(11)
    v_mfma_f32_16x16x32_bf16 v[192:195], a[32:35], v[112:115], v[192:195]
    ds_read_b128 v[160:163], v16 offset:1024
    v_mfma_f32_16x16x32_bf16 v[200:203], a[96:99], v[112:115], v[200:203]
    s_waitcnt lgkmcnt(11)
    v_mfma_f32_16x16x32_bf16 v[192:195], a[36:39], v[116:119], v[192:195]
    ds_read_b128 v[164:167], v16 offset:3072
    v_mfma_f32_16x16x32_bf16 v[200:203], a[100:103], v[116:119], v[200:203]
    s_waitcnt lgkmcnt(11)
    v_mfma_f32_16x16x32_bf16 v[192:195], a[40:43], v[120:123], v[192:195]
    ds_read_b128 v[168:171], v16 offset:5120
    v_mfma_f32_16x16x32_bf16 v[200:203], a[104:107], v[120:123], v[200:203]
    s_waitcnt lgkmcnt(11)
    v_mfma_f32_16x16x32_bf16 v[192:195], a[44:47], v[124:127], v[192:195]
    ds_read_b128 v[172:175], v16 offset:7168
    v_mfma_f32_16x16x32_bf16 v[200:203], a[108:111], v[124:127], v[200:203]
    s_waitcnt lgkmcnt(11)
    v_mfma_f32_16x16x32_bf16 v[192:195], a[48:51], v[128:131], v[192:195]
    ds_read_b128 v[176:179], v17 offset:1024
    v_mfma_f32_16x16x32_bf16 v[200:203], a[112:115], v[128:131], v[200:203]
    s_waitcnt lgkmcnt(11)
    v_mfma_f32_16x16x32_bf16 v[192:195], a[52:55], v[132:135], v[192:195]
    ds_read_b128 v[180:183], v17 offset:3072
    v_mfma_f32_16x16x32_bf16 v[200:203], a[116:119], v[132:135], v[200:203]
    s_waitcnt lgkmcnt(11)
    v_mfma_f32_16x16x32_bf16 v[192:195], a[56:59], v[136:139], v[192:195]
    ds_read_b128 v[184:187], v17 offset:5120
    v_mfma_f32_16x16x32_bf16 v[200:203], a[120:123], v[136:139], v[200:203]
    s_waitcnt lgkmcnt(11)
    v_mfma_f32_16x16x32_bf16 v[192:195], a[60:63], v[140:143], v[192:195]
    ds_read_b128 v[188:191], v17 offset:7168
    v_mfma_f32_16x16x32_bf16 v[200:203], a[124:127], v[140:143], v[200:203]
    v_mfma_f32_16x16x32_bf16 v[196:199], a[8:11], v[84:87], v[196:199]
    v_mfma_f32_16x16x32_bf16 v[204:207], a[72:75], v[84:87], v[204:207]
    s_waitcnt lgkmcnt(8)
    v_mfma_f32_16x16x32_bf16 v[196:199], a[12:15], v[92:95], v[196:199]
    v_max3_f32 v8, v192, v193, v194
    v_max3_f32 v9, v195, v200, v201
    v_mfma_f32_16x16x32_bf16 v[204:207], a[76:79], v[92:95], v[204:207]
    v_max3_f32 v8, v8, v202, v203
    v_max_f32 v8, v8, v9
    ds_max_f32 v20, v8 offset:0
    v_mfma_f32_16x16x32_bf16 v[196:199], a[16:19], v[144:147], v[196:199]
    v_mfma_f32_16x16x32_bf16 v[204:207], a[80:83], v[144:147], v[204:207]
    v_mfma_f32_16x16x32_bf16 v[196:199], a[20:23], v[148:151], v[196:199]
    s_waitcnt lgkmcnt(0)
    s_barrier
    ds_read_b32 v28, v20 offset:0
    v_mfma_f32_16x16x32_bf16 v[204:207], a[84:87], v[148:151], v[204:207]
    v_mfma_f32_16x16x32_bf16 v[196:199], a[24:27], v[152:155], v[196:199]
    v_mfma_f32_16x16x32_bf16 v[204:207], a[88:91], v[152:155], v[204:207]
    s_waitcnt lgkmcnt(0)
    v_mfma_f32_16x16x32_bf16 v[196:199], a[28:31], v[156:159], v[196:199]
    v_mul_f32 v28, s38, v28
    v_ceil_f32 v28, v28
    v_fma_f32 v192, v192, s38, -v28
    v_mfma_f32_16x16x32_bf16 v[204:207], a[92:95], v[156:159], v[204:207]
    v_fma_f32 v193, v193, s38, -v28
    v_fma_f32 v194, v194, s38, -v28
    v_fma_f32 v195, v195, s38, -v28
    v_mfma_f32_16x16x32_bf16 v[196:199], a[32:35], v[160:163], v[196:199]
    v_fma_f32 v200, v200, s38, -v28
    v_fma_f32 v201, v201, s38, -v28
    v_fma_f32 v202, v202, s38, -v28
    v_mfma_f32_16x16x32_bf16 v[204:207], a[96:99], v[160:163], v[204:207]
    v_fma_f32 v203, v203, s38, -v28
    v_exp_f32 v192, v192
    v_mfma_f32_16x16x32_bf16 v[196:199], a[36:39], v[164:167], v[196:199]
    v_exp_f32 v193, v193
    v_mfma_f32_16x16x32_bf16 v[204:207], a[100:103], v[164:167], v[204:207]
    v_exp_f32 v194, v194
    v_mfma_f32_16x16x32_bf16 v[196:199], a[40:43], v[168:171], v[196:199]
    v_exp_f32 v195, v195
    v_mfma_f32_16x16x32_bf16 v[204:207], a[104:107], v[168:171], v[204:207]
    v_exp_f32 v200, v200
    v_mfma_f32_16x16x32_bf16 v[196:199], a[44:47], v[172:175], v[196:199]
    v_exp_f32 v201, v201
    v_mfma_f32_16x16x32_bf16 v[204:207], a[108:111], v[172:175], v[204:207]
    v_exp_f32 v202, v202
    v_mfma_f32_16x16x32_bf16 v[196:199], a[48:51], v[176:179], v[196:199]
    v_exp_f32 v203, v203
    v_cvt_pk_bf16_f32 v208, v192, v193
    v_mfma_f32_16x16x32_bf16 v[204:207], a[112:115], v[176:179], v[204:207]
    v_cvt_pk_bf16_f32 v209, v194, v195
    v_cvt_pk_bf16_f32 v210, v200, v201
    v_cvt_pk_bf16_f32 v211, v202, v203
    ds_write_b128 v18, v[208:211] offset:0
    s_nop 0
    v_mfma_f32_16x16x32_bf16 v[192:195], v[24:27], v[208:211], 0
    v_mfma_f32_16x16x32_bf16 v[196:199], a[52:55], v[180:183], v[196:199]
    v_cvt_i32_f32 v28, v28
    v_lshl_or_b32 v28, v28, 16, s46
    v_mfma_f32_16x16x32_bf16 v[204:207], a[116:119], v[180:183], v[204:207]
    ds_write_b32 v12, v192 offset:256
    v_mfma_f32_16x16x32_bf16 v[196:199], a[56:59], v[184:187], v[196:199]
    s_waitcnt lgkmcnt(0)
    s_barrier
    ds_read_b128 v[64:67], v19 offset:0
    ds_read_b128 v[68:71], v19 offset:1024
    ds_read_b128 v[72:75], v19 offset:2048
    ds_read_b128 v[76:79], v19 offset:3072
    ds_read_b128 v[228:231], v20 offset:256
    v_mfma_f32_16x16x32_bf16 v[204:207], a[120:123], v[184:187], v[204:207]
    v_mfma_f32_16x16x32_bf16 v[196:199], a[60:63], v[188:191], v[196:199]
    v_mfma_f32_16x16x32_bf16 v[204:207], a[124:127], v[188:191], v[204:207]
    s_waitcnt lgkmcnt(0)
    v_mfma_f32_16x16x32_bf16 v[96:99], v[64:67], a[128:131], 0
    v_mfma_f32_16x16x32_bf16 v[100:103], v[64:67], a[144:147], 0
    v_mfma_f32_16x16x32_bf16 v[96:99], v[68:71], a[132:135], v[96:99]
    v_max3_f32 v8, v196, v197, v198
    v_max3_f32 v9, v199, v204, v205
    v_mfma_f32_16x16x32_bf16 v[100:103], v[68:71], a[148:151], v[100:103]
    v_max3_f32 v8, v8, v206, v207
    v_max_f32 v8, v8, v9
    ds_max_f32 v20, v8 offset:4
    v_mfma_f32_16x16x32_bf16 v[96:99], v[72:75], a[136:139], v[96:99]
    v_mfma_f32_16x16x32_bf16 v[100:103], v[72:75], a[152:155], v[100:103]
    v_mfma_f32_16x16x32_bf16 v[96:99], v[76:79], a[140:143], v[96:99]
    s_waitcnt lgkmcnt(0)
    s_barrier
    ds_read_b32 v30, v20 offset:4
    v_mfma_f32_16x16x32_bf16 v[100:103], v[76:79], a[156:159], v[100:103]
    v_mfma_f32_16x16x32_bf16 v[104:107], v[64:67], a[160:163], 0
    v_mfma_f32_16x16x32_bf16 v[108:111], v[64:67], a[176:179], 0
    s_waitcnt lgkmcnt(0)
    v_mfma_f32_16x16x32_bf16 v[104:107], v[68:71], a[164:167], v[104:107]
    v_mul_f32 v30, s38, v30
    v_ceil_f32 v30, v30
    v_fma_f32 v196, v196, s38, -v30
    v_mfma_f32_16x16x32_bf16 v[108:111], v[68:71], a[180:183], v[108:111]
    v_fma_f32 v197, v197, s38, -v30
    v_fma_f32 v198, v198, s38, -v30
    v_fma_f32 v199, v199, s38, -v30
    v_mfma_f32_16x16x32_bf16 v[104:107], v[72:75], a[168:171], v[104:107]
    v_fma_f32 v204, v204, s38, -v30
    v_fma_f32 v205, v205, s38, -v30
    v_fma_f32 v206, v206, s38, -v30
    v_mfma_f32_16x16x32_bf16 v[108:111], v[72:75], a[184:187], v[108:111]
    v_fma_f32 v207, v207, s38, -v30
    v_exp_f32 v196, v196
    v_mfma_f32_16x16x32_bf16 v[104:107], v[76:79], a[172:175], v[104:107]
    v_exp_f32 v197, v197
    v_mfma_f32_16x16x32_bf16 v[108:111], v[76:79], a[188:191], v[108:111]
    v_exp_f32 v198, v198
    v_mfma_f32_16x16x32_bf16 v[112:115], v[64:67], a[192:195], 0
    v_exp_f32 v199, v199
    v_mfma_f32_16x16x32_bf16 v[116:119], v[64:67], a[208:211], 0
    v_exp_f32 v204, v204
    v_mfma_f32_16x16x32_bf16 v[112:115], v[68:71], a[196:199], v[112:115]
    v_exp_f32 v205, v205
    v_mfma_f32_16x16x32_bf16 v[116:119], v[68:71], a[212:215], v[116:119]
    v_exp_f32 v206, v206
    v_mfma_f32_16x16x32_bf16 v[112:115], v[72:75], a[200:203], v[112:115]
    v_exp_f32 v207, v207
    v_cvt_pk_bf16_f32 v208, v196, v197
    v_mfma_f32_16x16x32_bf16 v[116:119], v[72:75], a[216:219], v[116:119]
    v_cvt_pk_bf16_f32 v209, v198, v199
    v_cvt_pk_bf16_f32 v210, v204, v205
    v_cvt_pk_bf16_f32 v211, v206, v207
    ds_write_b128 v18, v[208:211] offset:4096
    s_nop 0
    v_mfma_f32_16x16x32_bf16 v[196:199], v[24:27], v[208:211], 0
    v_mfma_f32_16x16x32_bf16 v[112:115], v[76:79], a[204:207], v[112:115]
    v_cvt_i32_f32 v30, v30
    v_lshl_or_b32 v30, v30, 16, s46
    v_mfma_f32_16x16x32_bf16 v[116:119], v[76:79], a[220:223], v[116:119]
    ds_write_b32 v12, v196 offset:512
    v_mfma_f32_16x16x32_bf16 v[120:123], v[64:67], a[224:227], 0
    v_cvt_pk_bf16_f32 v128, v96, v100
    v_and_or_b32 v128, v128, v5, s40
    v_mfma_f32_16x16x32_bf16 v[124:127], v[64:67], a[240:243], 0
    v_cvt_pk_bf16_f32 v132, v97, v101
    v_and_or_b32 v132, v132, v5, s40
    v_mfma_f32_16x16x32_bf16 v[120:123], v[68:71], a[228:231], v[120:123]
    v_cvt_pk_bf16_f32 v136, v98, v102
    v_and_or_b32 v136, v136, v5, s40
    v_mfma_f32_16x16x32_bf16 v[124:127], v[68:71], a[244:247], v[124:127]
    v_cvt_pk_bf16_f32 v140, v99, v103
    v_and_or_b32 v140, v140, v5, s40
    v_mfma_f32_16x16x32_bf16 v[120:123], v[72:75], a[232:235], v[120:123]
    s_waitcnt lgkmcnt(0)
    s_barrier
    ds_read_b128 v[80:83], v19 offset:4096
    ds_read_b128 v[84:87], v19 offset:5120
    ds_read_b128 v[88:91], v19 offset:6144
    ds_read_b128 v[92:95], v19 offset:7168
    ds_read_b128 v[232:235], v20 offset:512
    v_mfma_f32_16x16x32_bf16 v[124:127], v[72:75], a[248:251], v[124:127]
    v_mfma_f32_16x16x32_bf16 v[120:123], v[76:79], a[236:239], v[120:123]
    v_mfma_f32_16x16x32_bf16 v[124:127], v[76:79], a[252:255], v[124:127]
    s_waitcnt lgkmcnt(0)
    v_mfma_f32_16x16x32_bf16 v[144:147], v[80:83], a[128:131], 0
    s_cmp_lg_u32 s35, 0
    s_cbranch_scc1 nml_2
    v_add_f32 v228, v228, v229
    v_add_f32 v230, v230, v231
    v_add_f32 v228, v228, v230
    s_mov_b64 exec, 0xffff
    v_and_or_b32 v29, v228, v6, s39
    buffer_store_dwordx2 v[28:29], v22, s[48:51], s75 offen sc1
    s_mov_b64 exec, -1
nml_2:
    v_mfma_f32_16x16x32_bf16 v[148:151], v[80:83], a[144:147], 0
    s_cmp_lg_u32 s35, 1
    s_cbranch_scc1 nml_3
    v_add_f32 v232, v232, v233
    v_add_f32 v234, v234, v235
    v_add_f32 v232, v232, v234
    s_mov_b64 exec, 0xffff
    v_and_or_b32 v31, v232, v6, s39
    buffer_store_dwordx2 v[30:31], v22, s[48:51], s75 offen sc1
    s_mov_b64 exec, -1
nml_3:
    v_mfma_f32_16x16x32_bf16 v[144:147], v[84:87], a[132:135], v[144:147]
    v_cvt_pk_bf16_f32 v129, v104, v108
    v_and_or_b32 v129, v129, v5, s41
    v_cvt_pk_bf16_f32 v133, v105, v109
    v_mfma_f32_16x16x32_bf16 v[148:151], v[84:87], a[148:151], v[148:151]
    v_and_or_b32 v133, v133, v5, s41
    v_cvt_pk_bf16_f32 v137, v106, v110
    v_and_or_b32 v137, v137, v5, s41
    v_mfma_f32_16x16x32_bf16 v[144:147], v[88:91], a[136:139], v[144:147]
    v_cvt_pk_bf16_f32 v141, v107, v111
    v_and_or_b32 v141, v141, v5, s41
    v_cvt_pk_bf16_f32 v130, v112, v116
    v_mfma_f32_16x16x32_bf16 v[148:151], v[88:91], a[152:155], v[148:151]
    v_and_or_b32 v130, v130, v5, s42
    v_cvt_pk_bf16_f32 v134, v113, v117
    v_and_or_b32 v134, v134, v5, s42
    v_mfma_f32_16x16x32_bf16 v[144:147], v[92:95], a[140:143], v[144:147]
    v_cvt_pk_bf16_f32 v138, v114, v118
    v_and_or_b32 v138, v138, v5, s42
    v_cvt_pk_bf16_f32 v142, v115, v119
    v_mfma_f32_16x16x32_bf16 v[148:151], v[92:95], a[156:159], v[148:151]
    v_and_or_b32 v142, v142, v5, s42
    v_cvt_pk_bf16_f32 v131, v120, v124
    v_and_or_b32 v131, v131, v5, s43
    v_mfma_f32_16x16x32_bf16 v[152:155], v[80:83], a[160:163], 0
    buffer_store_dwordx4 v[128:131], v21, s[48:51], s74 offen sc1
    v_cvt_pk_bf16_f32 v135, v121, v125
    v_and_or_b32 v135, v135, v5, s43
    v_mfma_f32_16x16x32_bf16 v[156:159], v[80:83], a[176:179], 0
    s_xor_b32 s74, s74, 132096
    buffer_store_dwordx4 v[132:135], v21, s[48:51], s74 offen sc1
    v_cvt_pk_bf16_f32 v139, v122, v126
    v_mfma_f32_16x16x32_bf16 v[152:155], v[84:87], a[164:167], v[152:155]
    v_and_or_b32 v139, v139, v5, s43
    s_xor_b32 s74, s74, 396288
    buffer_store_dwordx4 v[136:139], v21, s[48:51], s74 offen sc1
    v_mfma_f32_16x16x32_bf16 v[156:159], v[84:87], a[180:183], v[156:159]
    v_cvt_pk_bf16_f32 v143, v123, v127
    v_and_or_b32 v143, v143, v5, s43
    s_xor_b32 s74, s74, 132096
    v_mfma_f32_16x16x32_bf16 v[152:155], v[88:91], a[168:171], v[152:155]
    buffer_store_dwordx4 v[140:143], v21, s[48:51], s74 offen sc1
    v_cvt_pk_bf16_f32 v176, v144, v148
    v_and_or_b32 v176, v176, v5, s40
    v_mfma_f32_16x16x32_bf16 v[156:159], v[88:91], a[184:187], v[156:159]
    v_cvt_pk_bf16_f32 v180, v145, v149
    v_and_or_b32 v180, v180, v5, s40
    v_cvt_pk_bf16_f32 v184, v146, v150
    v_mfma_f32_16x16x32_bf16 v[152:155], v[92:95], a[172:175], v[152:155]
    v_and_or_b32 v184, v184, v5, s40
    v_cvt_pk_bf16_f32 v188, v147, v151
    v_and_or_b32 v188, v188, v5, s40
    v_mfma_f32_16x16x32_bf16 v[156:159], v[92:95], a[188:191], v[156:159]
    s_nop 7
    v_cvt_pk_bf16_f32 v177, v152, v156
    v_and_or_b32 v177, v177, v5, s41
    v_cvt_pk_bf16_f32 v181, v153, v157
    v_mfma_f32_16x16x32_bf16 v[160:163], v[80:83], a[192:195], 0
    v_and_or_b32 v181, v181, v5, s41
    v_cvt_pk_bf16_f32 v185, v154, v158
    v_and_or_b32 v185, v185, v5, s41
    v_mfma_f32_16x16x32_bf16 v[164:167], v[80:83], a[208:211], 0
    v_cvt_pk_bf16_f32 v189, v155, v159
    v_and_or_b32 v189, v189, v5, s41
    v_mfma_f32_16x16x32_bf16 v[160:163], v[84:87], a[196:199], v[160:163]
    v_mfma_f32_16x16x32_bf16 v[164:167], v[84:87], a[212:215], v[164:167]
    v_mfma_f32_16x16x32_bf16 v[160:163], v[88:91], a[200:203], v[160:163]
    v_mfma_f32_16x16x32_bf16 v[164:167], v[88:91], a[216:219], v[164:167]
    v_mfma_f32_16x16x32_bf16 v[160:163], v[92:95], a[204:207], v[160:163]
    v_mfma_f32_16x16x32_bf16 v[164:167], v[92:95], a[220:223], v[164:167]
    v_mfma_f32_16x16x32_bf16 v[168:171], v[80:83], a[224:227], 0
    v_mfma_f32_16x16x32_bf16 v[172:175], v[80:83], a[240:243], 0
    v_mfma_f32_16x16x32_bf16 v[168:171], v[84:87], a[228:231], v[168:171]
    v_cvt_pk_bf16_f32 v178, v160, v164
    v_and_or_b32 v178, v178, v5, s42
    v_cvt_pk_bf16_f32 v182, v161, v165
    v_mfma_f32_16x16x32_bf16 v[172:175], v[84:87], a[244:247], v[172:175]
    v_and_or_b32 v182, v182, v5, s42
    v_cvt_pk_bf16_f32 v186, v162, v166
    v_and_or_b32 v186, v186, v5, s42
    v_mfma_f32_16x16x32_bf16 v[168:171], v[88:91], a[232:235], v[168:171]
    v_cvt_pk_bf16_f32 v190, v163, v167
    v_and_or_b32 v190, v190, v5, s42
    v_mfma_f32_16x16x32_bf16 v[172:175], v[88:91], a[248:251], v[172:175]
    v_mfma_f32_16x16x32_bf16 v[168:171], v[92:95], a[236:239], v[168:171]
    v_mfma_f32_16x16x32_bf16 v[172:175], v[92:95], a[252:255], v[172:175]
    s_nop 7
    v_cvt_pk_bf16_f32 v179, v168, v172
    v_and_or_b32 v179, v179, v5, s43
    buffer_store_dwordx4 v[176:179], v21, s[48:51], s47 offen sc1
    v_cvt_pk_bf16_f32 v183, v169, v173
    v_and_or_b32 v183, v183, v5, s43
    s_xor_b32 s47, s47, 132096
    buffer_store_dwordx4 v[180:183], v21, s[48:51], s47 offen sc1
    v_cvt_pk_bf16_f32 v187, v170, v174
    v_and_or_b32 v187, v187, v5, s43
    s_xor_b32 s47, s47, 396288
    buffer_store_dwordx4 v[184:187], v21, s[48:51], s47 offen sc1
    v_cvt_pk_bf16_f32 v191, v171, v175
    v_and_or_b32 v191, v191, v5, s43
    s_xor_b32 s47, s47, 132096
    buffer_store_dwordx4 v[188:191], v21, s[48:51], s47 offen sc1
    s_lshl_b32 s24, s44, 10
    s_add_u32 s24, s24, 98304
    s_and_b32 s69, s35, 1
    s_lshl_b32 s69, s69, 6
    s_and_b32 s70, s35, 2
    s_lshl_b32 s70, s70, 8
    s_add_u32 s69, s69, s70
    v_lshlrev_b32 v8, 3, v1
    v_xor_b32 v8, s69, v8
    v_xor_b32 v9, 512, v8
    s_lshl2_add_u32 s70, s44, s45
    s_lshl2_add_u32 s70, s70, s35
    s_lshl_b32 s70, s70, 13
    s_add_u32 s25, s70, 1048576
    s_add_u32 s27, s70, 1052672
    s_lshl_b32 s70, s35, 1
    v_lshrrev_b32 v11, 2, v3
    v_mul_u32_u24 v10, 1024, v2
    v_lshl_add_u32 v10, v11, 8, v10
    v_xor_b32 v11, s70, v11
    v_lshl_add_u32 v10, v11, 5, v10
    v_and_b32 v11, 3, v1
    v_lshl_add_u32 v10, v11, 3, v10
    v_add_u32 v10, 131072, v10
    v_xor_b32 v11, 32, v10
    ds_read_b64_tr_b16 a[0:1], v10 offset:0
    ds_read_b64_tr_b16 a[2:3], v10 offset:4096
    ds_read_b64_tr_b16 a[4:5], v11 offset:0
    ds_read_b64_tr_b16 a[6:7], v11 offset:4096
    ds_read_b64_tr_b16 a[8:9], v10 offset:8192
    ds_read_b64_tr_b16 a[10:11], v10 offset:12288
    ds_read_b64_tr_b16 a[12:13], v11 offset:8192
    ds_read_b64_tr_b16 a[14:15], v11 offset:12288
    ds_read_b64_tr_b16 a[16:17], v10 offset:16384
    ds_read_b64_tr_b16 a[18:19], v10 offset:20480
    ds_read_b64_tr_b16 a[20:21], v11 offset:16384
    ds_read_b64_tr_b16 a[22:23], v11 offset:20480
    ds_read_b64_tr_b16 a[24:25], v10 offset:24576
    ds_read_b64_tr_b16 a[26:27], v10 offset:28672
    ds_read_b64_tr_b16 a[28:29], v11 offset:24576
    ds_read_b64_tr_b16 a[30:31], v11 offset:28672
    v_mov_b32 v48, 0
    v_mov_b32 v49, 0
    v_mov_b32 v50, 0
    v_mov_b32 v51, 0
    v_mov_b32 v52, 0
    v_mov_b32 v53, 0
    v_mov_b32 v54, 0
    v_mov_b32 v55, 0
    s_mul_i32 s70, s35, 272
    s_add_u32 s70, s70, 82944
    v_lshlrev_b32 v18, 4, v3
    v_lshl_add_u32 v18, v2, 2, v18
    v_and_b32 v19, 3, v3
    v_lshrrev_b32 v18, 2, v3
    v_lshlrev_b32 v18, 4, v18
    v_lshl_add_u32 v18, v2, 6, v18
    v_lshl_add_u32 v18, v19, 1, v18
    v_add_u32 v18, s70, v18
    v_mul_u32_u24 v19, 272, v19
    v_lshl_add_u32 v19, v2, 4, v19
    v_add_u32 v19, 82944, v19
    v_lshlrev_b32 v20, 1, v1
    v_lshrrev_b32 v11, 2, v1
    v_lshlrev_b32 v10, 7, v11
    v_lshrrev_b32 v11, 1, v11
    v_and_b32 v11, 3, v11
    v_xor_b32 v11, s35, v11
    v_lshl_add_u32 v10, v11, 5, v10
    v_and_b32 v11, 3, v1
    v_lshl_add_u32 v10, v11, 3, v10
    v_add_u32 v11, 0x8000, v10
L_mln:
    s_waitcnt vmcnt(0)
L_ml:
    buffer_load_dwordx2 v[12:13], v8, s[48:51], s24 offen sc1
    buffer_load_dwordx2 v[14:15], v9, s[48:51], s24 offen sc1
    s_add_u32 s96, s96, 1
    s_cmp_ge_u32 s96, 40000
    s_cbranch_scc1 L_done
    s_waitcnt vmcnt(0)
L_mlp:
    v_xor_b32 v16, s34, v12
    v_xor_b32 v17, s34, v13
    v_bitop3_b32 v16, v14, s34, v16 bitop3:0xbe
    v_bitop3_b32 v17, v15, s34, v17 bitop3:0xbe
    v_lshlrev_b32 v16, 16, v16
    v_lshl_or_b32 v16, v17, 24, v16
    v_cmp_ne_u32 vcc, 0, v16
    v_max_i32 v16, v12, v14
    s_cbranch_vccnz L_ml
    buffer_load_dwordx4 v[64:67], v4, s[48:51], s25 offen sc1
    buffer_load_dwordx4 v[68:71], v4, s[48:51], s25 offen offset:1024 sc1
    buffer_load_dwordx4 v[72:75], v4, s[48:51], s25 offen offset:2048 sc1
    buffer_load_dwordx4 v[76:79], v4, s[48:51], s25 offen offset:3072 sc1
    buffer_load_dwordx4 v[80:83], v4, s[48:51], s27 offen sc1
    buffer_load_dwordx4 v[84:87], v4, s[48:51], s27 offen offset:1024 sc1
    buffer_load_dwordx4 v[88:91], v4, s[48:51], s27 offen offset:2048 sc1
    buffer_load_dwordx4 v[92:95], v4, s[48:51], s27 offen offset:3072 sc1
L_mlo:
    s_cmp_ge_u32 s37, 9
    s_cbranch_scc1 L_nw
    s_lshl2_add_u32 s72, s37, s35
    s_lshl_b32 s73, s72, 5
    s_lshl_b32 s74, s72, 6
    s_add_u32 s74, s74, 229376
    s_add_u32 s75, s74, 9216
    s_add_u32 s26, s74, 18432
    v_mov_b32 v27, v23
    v_lshlrev_b32 v23, 1, v3
    v_lshlrev_b32 v22, 2, v3
    v_add_u32 v21, 4608, v22
    buffer_load_ushort v26, v23, s[60:63], s73 offen
    buffer_load_dword v24, v22, s[48:51], s74 offen sc1
    buffer_load_dword v25, v21, s[48:51], s74 offen sc1
    buffer_load_dword v28, v22, s[48:51], s75 offen sc1
    buffer_load_dword v30, v21, s[48:51], s75 offen sc1
    buffer_load_dword v29, v22, s[48:51], s26 offen sc1
    buffer_load_dword v31, v21, s[48:51], s26 offen sc1
    s_barrier
    ds_read_b64_tr_b16 a[32:33], v10 offset:0
    ds_read_b64_tr_b16 a[34:35], v10 offset:2048
    ds_read_b64_tr_b16 a[36:37], v10 offset:4096
    ds_read_b64_tr_b16 a[38:39], v10 offset:6144
    ds_read_b64_tr_b16 a[40:41], v10 offset:8192
    ds_read_b64_tr_b16 a[42:43], v10 offset:10240
    ds_read_b64_tr_b16 a[44:45], v10 offset:12288
    ds_read_b64_tr_b16 a[46:47], v10 offset:14336
    ds_read_b64_tr_b16 a[48:49], v10 offset:16384
    ds_read_b64_tr_b16 a[50:51], v10 offset:18432
    ds_read_b64_tr_b16 a[52:53], v10 offset:20480
    ds_read_b64_tr_b16 a[54:55], v10 offset:22528
    ds_read_b64_tr_b16 a[56:57], v10 offset:24576
    ds_read_b64_tr_b16 a[58:59], v10 offset:26624
    ds_read_b64_tr_b16 a[60:61], v10 offset:28672
    ds_read_b64_tr_b16 a[62:63], v10 offset:30720
    s_lshl_b32 m0, s35, 10
    s_add_u32 m0, m0, 32768
L_nw:
    v_max_i32_dpp v16, v16, v16 row_ror:8 row_mask:0xf bank_mask:0xf
    s_nop 1
    v_max_i32_dpp v16, v16, v16 row_ror:4 row_mask:0xf bank_mask:0xf
    s_nop 1
    v_max_i32_dpp v16, v16, v16 row_ror:2 row_mask:0xf bank_mask:0xf
    s_nop 1
    v_max_i32_dpp v16, v16, v16 row_ror:1 row_mask:0xf bank_mask:0xf
    v_mov_b32 v17, v16
    s_nop 1
    v_permlane16_swap_b32 v16, v17
    v_max_i32 v16, v16, v17
    v_mov_b32 v17, v16
    s_nop 1
    v_permlane32_swap_b32 v16, v17
    v_max_i32 v16, v16, v17
    v_sub_u32 v12, v12, v16
    v_sub_u32 v14, v14, v16
    v_ashrrev_i32 v12, 16, v12
    v_ashrrev_i32 v14, 16, v14
    v_add_u32 v12, 127, v12
    v_add_u32 v14, 127, v14
    v_max_i32 v12, 0, v12
    v_max_i32 v14, 0, v14
    v_lshlrev_b32 v17, 7, v12
    v_lshlrev_b32 v12, 23, v12
    v_lshlrev_b32 v14, 23, v14
    v_mov_b32_dpp v40, v17 row_newbcast:0 row_mask:0xf bank_mask:0xf
    v_mov_b32_dpp v32, v12 row_newbcast:0 row_mask:0xf bank_mask:0xf
    v_mov_b32_dpp v41, v17 row_newbcast:1 row_mask:0xf bank_mask:0xf
    v_mov_b32_dpp v33, v12 row_newbcast:1 row_mask:0xf bank_mask:0xf
    v_mov_b32_dpp v42, v17 row_newbcast:2 row_mask:0xf bank_mask:0xf
    v_mov_b32_dpp v34, v12 row_newbcast:2 row_mask:0xf bank_mask:0xf
    v_mov_b32_dpp v43, v17 row_newbcast:3 row_mask:0xf bank_mask:0xf
    v_mov_b32_dpp v35, v12 row_newbcast:3 row_mask:0xf bank_mask:0xf
    v_mov_b32_dpp v44, v17 row_newbcast:4 row_mask:0xf bank_mask:0xf
    v_mov_b32_dpp v36, v12 row_newbcast:4 row_mask:0xf bank_mask:0xf
    v_mov_b32_dpp v45, v17 row_newbcast:5 row_mask:0xf bank_mask:0xf
    v_mov_b32_dpp v37, v12 row_newbcast:5 row_mask:0xf bank_mask:0xf
    v_mov_b32_dpp v46, v17 row_newbcast:6 row_mask:0xf bank_mask:0xf
    v_mov_b32_dpp v38, v12 row_newbcast:6 row_mask:0xf bank_mask:0xf
    v_mov_b32_dpp v47, v17 row_newbcast:7 row_mask:0xf bank_mask:0xf
    v_mov_b32_dpp v39, v12 row_newbcast:7 row_mask:0xf bank_mask:0xf
    v_mul_f32 v16, v12, v13
    v_fmac_f32 v16, v14, v15
    s_nop 1
    v_add_f32_dpp v16, v16, v16 row_ror:8 row_mask:0xf bank_mask:0xf
    s_nop 1
    v_add_f32_dpp v16, v16, v16 row_ror:4 row_mask:0xf bank_mask:0xf
    s_nop 1
    v_add_f32_dpp v16, v16, v16 row_ror:2 row_mask:0xf bank_mask:0xf
    s_nop 1
    v_add_f32_dpp v16, v16, v16 row_ror:1 row_mask:0xf bank_mask:0xf
    v_mov_b32 v17, v16
    s_nop 1
    v_permlane16_swap_b32 v16, v17
    v_add_f32 v16, v16, v17
    v_mov_b32 v17, v16
    s_nop 1
    v_permlane32_swap_b32 v16, v17
    v_add_f32 v16, v16, v17
    v_rcp_f32 v16, v16
    s_mov_b64 s[100:101], 0
    s_cmp_ge_u32 s37, 9
    s_cbranch_scc1 L_op2
    s_waitcnt vmcnt(14)
    v_xor_b32 v17, s40, v64
    v_bitop3_b32 v17, v65, s41, v17 bitop3:0xbe
    v_bitop3_b32 v17, v66, s42, v17 bitop3:0xbe
    v_bitop3_b32 v17, v67, s43, v17 bitop3:0xbe
    v_and_b32 v17, 0x10001, v17
    v_cmp_ne_u32 vcc, 0, v17
    s_wqm_b64 s[4:5], vcc
    s_andn2_b64 exec, exec, s[4:5]
    s_or_b64 s[100:101], s[100:101], vcc
    v_dot2c_f32_bf16 v48, v64, v40
    v_dot2c_f32_bf16 v49, v64, v32
    v_dot2c_f32_bf16 v50, v65, v40
    v_dot2c_f32_bf16 v51, v65, v32
    v_dot2c_f32_bf16 v52, v66, v40
    v_dot2c_f32_bf16 v53, v66, v32
    v_dot2c_f32_bf16 v54, v67, v40
    v_dot2c_f32_bf16 v55, v67, v32
    s_mov_b64 exec, -1
    buffer_load_dwordx4 v27, s[52:55], s68 offen nt lds
    s_add_u32 s68, s68, 36864
    s_add_u32 m0, m0, 4096
    s_waitcnt vmcnt(14)
    v_xor_b32 v17, s40, v68
    v_bitop3_b32 v17, v69, s41, v17 bitop3:0xbe
    v_bitop3_b32 v17, v70, s42, v17 bitop3:0xbe
    v_bitop3_b32 v17, v71, s43, v17 bitop3:0xbe
    v_and_b32 v17, 0x10001, v17
    v_cmp_ne_u32 vcc, 0, v17
    s_wqm_b64 s[6:7], vcc
    s_andn2_b64 exec, exec, s[6:7]
    s_or_b64 s[100:101], s[100:101], vcc
    v_dot2c_f32_bf16 v48, v68, v41
    v_dot2c_f32_bf16 v49, v68, v33
    v_dot2c_f32_bf16 v50, v69, v41
    v_dot2c_f32_bf16 v51, v69, v33
    v_dot2c_f32_bf16 v52, v70, v41
    v_dot2c_f32_bf16 v53, v70, v33
    v_dot2c_f32_bf16 v54, v71, v41
    v_dot2c_f32_bf16 v55, v71, v33
    s_mov_b64 exec, -1
    buffer_load_dwordx4 v27, s[52:55], s68 offen nt lds
    s_add_u32 s68, s68, 36864
    s_add_u32 m0, m0, 4096
    s_waitcnt vmcnt(14)
    v_xor_b32 v17, s40, v72
    v_bitop3_b32 v17, v73, s41, v17 bitop3:0xbe
    v_bitop3_b32 v17, v74, s42, v17 bitop3:0xbe
    v_bitop3_b32 v17, v75, s43, v17 bitop3:0xbe
    v_and_b32 v17, 0x10001, v17
    v_cmp_ne_u32 vcc, 0, v17
    s_wqm_b64 s[8:9], vcc
    s_andn2_b64 exec, exec, s[8:9]
    s_or_b64 s[100:101], s[100:101], vcc
    v_dot2c_f32_bf16 v48, v72, v42
    v_dot2c_f32_bf16 v49, v72, v34
    v_dot2c_f32_bf16 v50, v73, v42
    v_dot2c_f32_bf16 v51, v73, v34
    v_dot2c_f32_bf16 v52, v74, v42
    v_dot2c_f32_bf16 v53, v74, v34
    v_dot2c_f32_bf16 v54, v75, v42
    v_dot2c_f32_bf16 v55, v75, v34
    s_mov_b64 exec, -1
    buffer_load_dwordx4 v27, s[52:55], s68 offen nt lds
    s_add_u32 s68, s68, 36864
    s_add_u32 m0, m0, 4096
    s_waitcnt vmcnt(14)
    v_xor_b32 v17, s40, v76
    v_bitop3_b32 v17, v77, s41, v17 bitop3:0xbe
    v_bitop3_b32 v17, v78, s42, v17 bitop3:0xbe
    v_bitop3_b32 v17, v79, s43, v17 bitop3:0xbe
    v_and_b32 v17, 0x10001, v17
    v_cmp_ne_u32 vcc, 0, v17
    s_wqm_b64 s[10:11], vcc
    s_andn2_b64 exec, exec, s[10:11]
    s_or_b64 s[100:101], s[100:101], vcc
    v_dot2c_f32_bf16 v48, v76, v43
    v_dot2c_f32_bf16 v49, v76, v35
    v_dot2c_f32_bf16 v50, v77, v43
    v_dot2c_f32_bf16 v51, v77, v35
    v_dot2c_f32_bf16 v52, v78, v43
    v_dot2c_f32_bf16 v53, v78, v35
    v_dot2c_f32_bf16 v54, v79, v43
    v_dot2c_f32_bf16 v55, v79, v35
    s_mov_b64 exec, -1
    buffer_load_dwordx4 v27, s[52:55], s68 offen nt lds
    s_add_u32 s68, s68, 36864
    s_add_u32 m0, m0, 4096
    s_waitcnt vmcnt(14)
    v_xor_b32 v17, s40, v80
    v_bitop3_b32 v17, v81, s41, v17 bitop3:0xbe
    v_bitop3_b32 v17, v82, s42, v17 bitop3:0xbe
    v_bitop3_b32 v17, v83, s43, v17 bitop3:0xbe
    v_and_b32 v17, 0x10001, v17
    v_cmp_ne_u32 vcc, 0, v17
    s_wqm_b64 s[12:13], vcc
    s_andn2_b64 exec, exec, s[12:13]
    s_or_b64 s[100:101], s[100:101], vcc
    v_dot2c_f32_bf16 v48, v80, v44
    v_dot2c_f32_bf16 v49, v80, v36
    v_dot2c_f32_bf16 v50, v81, v44
    v_dot2c_f32_bf16 v51, v81, v36
    v_dot2c_f32_bf16 v52, v82, v44
    v_dot2c_f32_bf16 v53, v82, v36
    v_dot2c_f32_bf16 v54, v83, v44
    v_dot2c_f32_bf16 v55, v83, v36
    s_mov_b64 exec, -1
    buffer_load_dwordx4 v27, s[52:55], s68 offen nt lds
    s_add_u32 s68, s68, 36864
    s_add_u32 m0, m0, 4096
    s_waitcnt vmcnt(14)
    v_xor_b32 v17, s40, v84
    v_bitop3_b32 v17, v85, s41, v17 bitop3:0xbe
    v_bitop3_b32 v17, v86, s42, v17 bitop3:0xbe
    v_bitop3_b32 v17, v87, s43, v17 bitop3:0xbe
    v_and_b32 v17, 0x10001, v17
    v_cmp_ne_u32 vcc, 0, v17
    s_wqm_b64 s[14:15], vcc
    s_andn2_b64 exec, exec, s[14:15]
    s_or_b64 s[100:101], s[100:101], vcc
    v_dot2c_f32_bf16 v48, v84, v45
    v_dot2c_f32_bf16 v49, v84, v37
    v_dot2c_f32_bf16 v50, v85, v45
    v_dot2c_f32_bf16 v51, v85, v37
    v_dot2c_f32_bf16 v52, v86, v45
    v_dot2c_f32_bf16 v53, v86, v37
    v_dot2c_f32_bf16 v54, v87, v45
    v_dot2c_f32_bf16 v55, v87, v37
    s_mov_b64 exec, -1
    buffer_load_dwordx4 v27, s[52:55], s68 offen nt lds
    s_add_u32 s68, s68, 36864
    s_add_u32 m0, m0, 4096
    s_waitcnt vmcnt(14)
    v_xor_b32 v17, s40, v88
    v_bitop3_b32 v17, v89, s41, v17 bitop3:0xbe
    v_bitop3_b32 v17, v90, s42, v17 bitop3:0xbe
    v_bitop3_b32 v17, v91, s43, v17 bitop3:0xbe
    v_and_b32 v17, 0x10001, v17
    v_cmp_ne_u32 vcc, 0, v17
    s_wqm_b64 s[16:17], vcc
    s_andn2_b64 exec, exec, s[16:17]
    s_or_b64 s[100:101], s[100:101], vcc
    v_dot2c_f32_bf16 v48, v88, v46
    v_dot2c_f32_bf16 v49, v88, v38
    v_dot2c_f32_bf16 v50, v89, v46
    v_dot2c_f32_bf16 v51, v89, v38
    v_dot2c_f32_bf16 v52, v90, v46
    v_dot2c_f32_bf16 v53, v90, v38
    v_dot2c_f32_bf16 v54, v91, v46
    v_dot2c_f32_bf16 v55, v91, v38
    s_mov_b64 exec, -1
    buffer_load_dwordx4 v27, s[52:55], s68 offen nt lds
    s_add_u32 s68, s68, 36864
    s_add_u32 m0, m0, 4096
    s_waitcnt vmcnt(14)
    v_xor_b32 v17, s40, v92
    v_bitop3_b32 v17, v93, s41, v17 bitop3:0xbe
    v_bitop3_b32 v17, v94, s42, v17 bitop3:0xbe
    v_bitop3_b32 v17, v95, s43, v17 bitop3:0xbe
    v_and_b32 v17, 0x10001, v17
    v_cmp_ne_u32 vcc, 0, v17
    s_wqm_b64 s[18:19], vcc
    s_andn2_b64 exec, exec, s[18:19]
    s_or_b64 s[100:101], s[100:101], vcc
    v_dot2c_f32_bf16 v48, v92, v47
    v_dot2c_f32_bf16 v49, v92, v39
    v_dot2c_f32_bf16 v50, v93, v47
    v_dot2c_f32_bf16 v51, v93, v39
    v_dot2c_f32_bf16 v52, v94, v47
    v_dot2c_f32_bf16 v53, v94, v39
    v_dot2c_f32_bf16 v54, v95, v47
    v_dot2c_f32_bf16 v55, v95, v39
    s_mov_b64 exec, -1
    buffer_load_dwordx4 v27, s[52:55], s68 offen nt lds
    s_add_u32 s68, s68, 36864
    s_add_u32 m0, m0, 4096
L_ope:
    s_cmp_lg_u64 s[100:101], 0
    s_cbranch_scc1 L_opr
    s_mov_b64 exec, -1
    v_permlane32_swap_b32 v48, v52
    v_permlane32_swap_b32 v49, v53
    v_permlane32_swap_b32 v50, v54
    v_permlane32_swap_b32 v51, v55
    v_add_f32 v48, v48, v52
    v_add_f32 v49, v49, v53
    v_add_f32 v50, v50, v54
    v_add_f32 v51, v51, v55
    s_nop 0
    v_permlane16_swap_b32 v48, v50
    v_permlane16_swap_b32 v49, v51
    v_add_f32 v48, v48, v50
    v_add_f32 v49, v49, v51
    v_cvt_pk_bf16_f32 v48, v48, v49
    ds_write_b16 v18, v48
    ds_write_b16_d16_hi v18, v48 offset:8
    s_add_u32 s70, s98, 131072
    s_add_u32 s71, s98, 196608
    s_mov_b32 s100, 0xffff0000
    s_mov_b32 s101, 0xffff0000
    s_waitcnt lgkmcnt(0)
    s_barrier
    ds_read_b128 v[32:35], v19 offset:0
    ds_read_b128 v[36:39], v19 offset:64
    ds_read_b128 v[40:43], v19 offset:128
    ds_read_b128 v[44:47], v19 offset:192
    s_waitcnt lgkmcnt(3)
    v_mfma_f32_16x16x32_bf16 v[48:51], v[32:35], a[0:3], 0
    v_mfma_f32_16x16x32_bf16 v[52:55], v[32:35], a[4:7], 0
    s_waitcnt lgkmcnt(2)
    v_mfma_f32_16x16x32_bf16 v[48:51], v[36:39], a[8:11], v[48:51]
    v_mfma_f32_16x16x32_bf16 v[52:55], v[36:39], a[12:15], v[52:55]
    s_waitcnt lgkmcnt(1)
    v_mfma_f32_16x16x32_bf16 v[48:51], v[40:43], a[16:19], v[48:51]
    v_mfma_f32_16x16x32_bf16 v[52:55], v[40:43], a[20:23], v[52:55]
    s_waitcnt lgkmcnt(0)
    v_mfma_f32_16x16x32_bf16 v[48:51], v[44:47], a[24:27], v[48:51]
    v_mfma_f32_16x16x32_bf16 v[52:55], v[44:47], a[28:31], v[52:55]
    s_nop 3
    v_add_f32 v48, v48, v49
    v_add_f32 v50, v50, v51
    s_nop 1
    v_add_f32 v52, v52, v53
    v_add_f32 v54, v54, v55
    v_add_f32 v48, v48, v50
    v_add_f32 v52, v52, v54
    v_cndmask_b32 v48, v48, v52, s[100:101]
    v_mul_f32 v48, v48, v16
    s_nop 1
    v_mov_b32_dpp v13, v48 quad_perm:[1,0,3,2] row_mask:0xf bank_mask:0xf
    v_cvt_pk_bf16_f32 v12, v48, v13
    v_and_or_b32 v12, v12, v5, v7
    s_nop 1
    v_mov_b32_dpp v13, v12 row_ror:14 row_mask:0xf bank_mask:0xf
    v_mov_b32_dpp v14, v12 row_ror:12 row_mask:0xf bank_mask:0xf
    v_mov_b32_dpp v15, v12 row_ror:10 row_mask:0xf bank_mask:0xf
    s_mov_b64 exec, 0x01010101
    buffer_store_dwordx4 v[12:15], v20, s[48:51], s70 offen
    s_cmp_ge_u32 s37, 9
    s_cbranch_scc1 L_nE2
    s_mov_b64 exec, -1
    v_lshlrev_b32 v8, 6, v3
    v_lshl_add_u32 v8, v2, 4, v8
    s_lshl_b32 s68, s36, 12
    s_add_u32 s68, s68, 131072
    buffer_load_dwordx4 v[32:35], v8, s[48:51], s68 offen sc1
    buffer_load_dwordx4 v[36:39], v8, s[48:51], s68 offen offset:1024 sc1
    buffer_load_dwordx4 v[40:43], v8, s[48:51], s68 offen offset:2048 sc1
    buffer_load_dwordx4 v[44:47], v8, s[48:51], s68 offen offset:3072 sc1
    s_mov_b32 s47, 0
    s_lshl_b32 s73, s72, 9
    s_lshl_b32 s69, s36, 6
    s_add_u32 s73, s73, s69
    s_add_u32 s73, s73, 278528
    s_mul_i32 s69, s36, 2304
    s_lshl_b32 s72, s72, 6
    s_add_u32 s72, s72, s69
    s_add_u32 s72, s72, 299008
    s_cmp_eq_u32 s36, 0
    s_cselect_b32 s69, -1, 0
    s_mov_b32 s4, 0
    s_mov_b32 s5, -1
    s_waitcnt vmcnt(5)
    s_barrier
    ds_read_b64_tr_b16 a[64:65], v11 offset:0
    ds_read_b64_tr_b16 a[66:67], v11 offset:2048
    ds_read_b64_tr_b16 a[68:69], v11 offset:4096
    ds_read_b64_tr_b16 a[70:71], v11 offset:6144
    ds_read_b64_tr_b16 a[72:73], v11 offset:8192
    ds_read_b64_tr_b16 a[74:75], v11 offset:10240
    ds_read_b64_tr_b16 a[76:77], v11 offset:12288
    ds_read_b64_tr_b16 a[78:79], v11 offset:14336
    ds_read_b64_tr_b16 a[80:81], v11 offset:16384
    ds_read_b64_tr_b16 a[82:83], v11 offset:18432
    ds_read_b64_tr_b16 a[84:85], v11 offset:20480
    ds_read_b64_tr_b16 a[86:87], v11 offset:22528
    ds_read_b64_tr_b16 a[88:89], v11 offset:24576
    ds_read_b64_tr_b16 a[90:91], v11 offset:26624
    ds_read_b64_tr_b16 a[92:93], v11 offset:28672
    ds_read_b64_tr_b16 a[94:95], v11 offset:30720
L_m2b:
    v_xor_b32 v9, s39, v24
    v_bitop3_b32 v9, v25, s39, v9 bitop3:0xbe
    v_bitop3_b32 v9, v28, s39, v9 bitop3:0xbe
    v_bitop3_b32 v9, v29, s39, v9 bitop3:0xbe
    v_bitop3_b32 v9, v30, s39, v9 bitop3:0xbe
    v_bitop3_b32 v9, v31, s39, v9 bitop3:0xbe
    v_and_b32 v9, 0xff, v9
    v_cmp_ne_u32 vcc, 0, v9
    s_cbranch_vccnz L_m2
    v_lshlrev_b32 v26, 16, v26
    v_and_b32 v26, s69, v26
    v_add_f32 v24, v24, v28
    v_add_f32 v25, v25, v30
    v_add_f32 v24, v24, v29
    v_add_f32 v25, v25, v31
    v_cvt_pk_bf16_f32 v24, v24, v25
    v_and_b32 v25, 0xffff0000, v24
    v_lshlrev_b32 v24, 16, v24
    v_add_f32 v25, 1.0, v25
    v_cvt_pk_bf16_f32 v25, v25, v25
    v_and_b32 v25, 0xffff0000, v25
    v_cndmask_b32 v25, 1.0, v25, s[100:101]
    s_branch L_cpb
L_cp:
    buffer_load_dwordx4 v[32:35], v8, s[48:51], s68 offen sc1
    buffer_load_dwordx4 v[36:39], v8, s[48:51], s68 offen offset:1024 sc1
    buffer_load_dwordx4 v[40:43], v8, s[48:51], s68 offen offset:2048 sc1
    buffer_load_dwordx4 v[44:47], v8, s[48:51], s68 offen offset:3072 sc1
    s_add_u32 s96, s96, 1
    s_cmp_ge_u32 s96, 40000
    s_cbranch_scc1 L_done
    s_add_u32 s47, s47, 1
    s_cmp_eq_u32 s47, 24
    s_cbranch_scc1 L_cpg
L_cpb:
    s_waitcnt vmcnt(0) lgkmcnt(0)
    v_mfma_f32_16x16x32_bf16 v[48:51], v[32:35], a[32:35], 0
    v_xor_b32 v9, s40, v32
    v_bitop3_b32 v9, v33, s41, v9 bitop3:0xbe
    v_bitop3_b32 v9, v34, s42, v9 bitop3:0xbe
    v_mfma_f32_16x16x32_bf16 v[48:51], v[36:39], a[36:39], v[48:51]
    v_bitop3_b32 v9, v35, s43, v9 bitop3:0xbe
    v_bitop3_b32 v9, v36, s40, v9 bitop3:0xbe
    v_bitop3_b32 v9, v37, s41, v9 bitop3:0xbe
    v_mfma_f32_16x16x32_bf16 v[48:51], v[40:43], a[40:43], v[48:51]
    v_bitop3_b32 v9, v38, s42, v9 bitop3:0xbe
    v_bitop3_b32 v9, v39, s43, v9 bitop3:0xbe
    v_bitop3_b32 v9, v40, s40, v9 bitop3:0xbe
    v_mfma_f32_16x16x32_bf16 v[48:51], v[44:47], a[44:47], v[48:51]
    v_bitop3_b32 v9, v41, s41, v9 bitop3:0xbe
    v_bitop3_b32 v9, v42, s42, v9 bitop3:0xbe
    v_bitop3_b32 v9, v43, s43, v9 bitop3:0xbe
    v_mfma_f32_16x16x32_bf16 v[52:55], v[32:35], a[48:51], 0
    v_bitop3_b32 v9, v44, s40, v9 bitop3:0xbe
    v_bitop3_b32 v9, v45, s41, v9 bitop3:0xbe
    v_bitop3_b32 v9, v46, s42, v9 bitop3:0xbe
    v_mfma_f32_16x16x32_bf16 v[52:55], v[36:39], a[52:55], v[52:55]
    v_bitop3_b32 v9, v47, s43, v9 bitop3:0xbe
    v_and_b32 v9, 0x10001, v9
    v_cmp_ne_u32 vcc, 0, v9
    s_cbranch_vccnz L_cp
    v_mfma_f32_16x16x32_bf16 v[52:55], v[40:43], a[56:59], v[52:55]
    v_add_f32 v48, v48, v49
    v_add_f32 v50, v50, v51
    v_mfma_f32_16x16x32_bf16 v[52:55], v[44:47], a[60:63], v[52:55]
    v_add_f32 v48, v48, v50
    v_mfma_f32_16x16x32_bf16 v[56:59], v[32:35], a[64:67], 0
    v_mfma_f32_16x16x32_bf16 v[56:59], v[36:39], a[68:71], v[56:59]
    v_mfma_f32_16x16x32_bf16 v[56:59], v[40:43], a[72:75], v[56:59]
    v_add_f32 v52, v52, v53
    v_add_f32 v54, v54, v55
    v_mfma_f32_16x16x32_bf16 v[56:59], v[44:47], a[76:79], v[56:59]
    v_add_f32 v52, v52, v54
    v_mfma_f32_16x16x32_bf16 v[60:63], v[32:35], a[80:83], 0
    v_cndmask_b32 v48, v48, v52, s[100:101]
    v_mfma_f32_16x16x32_bf16 v[60:63], v[36:39], a[84:87], v[60:63]
    v_mfma_f32_16x16x32_bf16 v[60:63], v[40:43], a[88:91], v[60:63]
    v_add_f32 v56, v56, v57
    v_add_f32 v58, v58, v59
    v_mfma_f32_16x16x32_bf16 v[60:63], v[44:47], a[92:95], v[60:63]
    v_add_f32 v56, v56, v58
    s_nop 6
    v_add_f32 v60, v60, v61
    v_add_f32 v62, v62, v63
    v_add_f32 v60, v60, v62
    v_cndmask_b32 v56, v56, v60, s[100:101]
    v_cndmask_b32 v48, v48, v56, s[4:5]
    v_mov_b32 v49, v48
    s_nop 1
    v_permlane16_swap_b32 v48, v49
    v_add_f32 v48, v48, v49
    v_mov_b32 v49, v48
    s_nop 1
    v_permlane32_swap_b32 v48, v49
    v_add_f32 v48, v48, v49
    v_fma_f32 v48, v48, v24, v26
    v_mul_f32 v49, v48, v25
    s_nop 1
    v_mov_b32_dpp v53, v49 quad_perm:[1,0,3,2] row_mask:0xf bank_mask:0xf
    v_cvt_pk_bf16_f32 v52, v49, v53
    v_and_or_b32 v52, v52, v5, v7
    s_nop 1
    v_mov_b32_dpp v53, v52 row_ror:14 row_mask:0xf bank_mask:0xf
    v_mov_b32_dpp v54, v52 row_ror:12 row_mask:0xf bank_mask:0xf
    v_mov_b32_dpp v55, v52 row_ror:10 row_mask:0xf bank_mask:0xf
    v_and_or_b32 v48, v48, v6, s39
    s_mov_b64 exec, 0x01010101
    buffer_store_dwordx4 v[52:55], v20, s[48:51], s73 offen sc1
    buffer_store_dwordx4 v[12:15], v20, s[48:51], s71 offen sc1
    s_mov_b64 exec, 0xffff
    buffer_store_dword v48, v22, s[48:51], s72 offen sc1
    s_branch L_done
L_xf:
    s_barrier
    s_and_b32 s68, s35, 1
    s_lshl_b32 s68, s68, 4
    s_and_b32 s69, s35, 2
    s_lshl_b32 s69, s69, 1
    s_add_u32 s68, s68, s69
    s_lshl_b32 s69, s97, 5
    s_add_u32 s68, s68, s69
    s_mul_i32 s68, s68, 1152
    s_add_u32 m0, s3, 110592
    s_nop 0
    buffer_load_dwordx4 v246, s[60:63], s68 offen nt lds
    s_add_u32 m0, s3, 114560
    s_nop 0
    buffer_load_dwordx4 v246, s[60:63], s68 offen offset:128 nt lds
    s_add_u32 m0, s3, 118528
    s_nop 0
    buffer_load_dwordx4 v246, s[60:63], s68 offen offset:256 nt lds
    s_add_u32 m0, s3, 122496
    s_nop 0
    buffer_load_dwordx4 v246, s[60:63], s68 offen offset:384 nt lds
    s_add_u32 m0, s3, 126464
    s_nop 0
    buffer_load_dwordx4 v246, s[60:63], s68 offen offset:512 nt lds
    s_add_u32 m0, s3, 130432
    s_nop 0
    buffer_load_dwordx4 v246, s[60:63], s68 offen offset:640 nt lds
    s_add_u32 m0, s3, 134400
    s_nop 0
    buffer_load_dwordx4 v246, s[60:63], s68 offen offset:768 nt lds
    s_add_u32 m0, s3, 138368
    s_nop 0
    buffer_load_dwordx4 v246, s[60:63], s68 offen offset:896 nt lds
    s_add_u32 m0, s3, 142336
    s_nop 0
    buffer_load_dwordx4 v246, s[60:63], s68 offen offset:1024 nt lds
    s_branch L_ft4
L_opr:
    s_mov_b64 exec, s[4:5]
    s_cbranch_execz L_opn0
    buffer_load_dwordx4 v[64:67], v4, s[48:51], s25 offen sc1
L_opn0:
    s_mov_b64 exec, s[6:7]
    s_cbranch_execz L_opn1
    buffer_load_dwordx4 v[68:71], v4, s[48:51], s25 offen offset:1024 sc1
L_opn1:
    s_mov_b64 exec, s[8:9]
    s_cbranch_execz L_opn2
    buffer_load_dwordx4 v[72:75], v4, s[48:51], s25 offen offset:2048 sc1
L_opn2:
    s_mov_b64 exec, s[10:11]
    s_cbranch_execz L_opn3
    buffer_load_dwordx4 v[76:79], v4, s[48:51], s25 offen offset:3072 sc1
L_opn3:
    s_mov_b64 exec, s[12:13]
    s_cbranch_execz L_opn4
    buffer_load_dwordx4 v[80:83], v4, s[48:51], s27 offen sc1
L_opn4:
    s_mov_b64 exec, s[14:15]
    s_cbranch_execz L_opn5
    buffer_load_dwordx4 v[84:87], v4, s[48:51], s27 offen offset:1024 sc1
L_opn5:
    s_mov_b64 exec, s[16:17]
    s_cbranch_execz L_opn6
    buffer_load_dwordx4 v[88:91], v4, s[48:51], s27 offen offset:2048 sc1
L_opn6:
    s_mov_b64 exec, s[18:19]
    s_cbranch_execz L_opn7
    buffer_load_dwordx4 v[92:95], v4, s[48:51], s27 offen offset:3072 sc1
L_opn7:
    s_mov_b64 exec, -1
    s_add_u32 s96, s96, 1
    s_cmp_ge_u32 s96, 40000
    s_cbranch_scc1 L_done
    s_waitcnt vmcnt(0)
    s_mov_b64 s[100:101], 0
    s_mov_b64 exec, s[4:5]
    s_cbranch_execz L_ops0
    v_xor_b32 v17, s40, v64
    v_bitop3_b32 v17, v65, s41, v17 bitop3:0xbe
    v_bitop3_b32 v17, v66, s42, v17 bitop3:0xbe
    v_bitop3_b32 v17, v67, s43, v17 bitop3:0xbe
    v_and_b32 v17, 0x10001, v17
    v_cmp_ne_u32 vcc, 0, v17
    s_wqm_b64 s[4:5], vcc
    s_andn2_b64 exec, exec, s[4:5]
    s_or_b64 s[100:101], s[100:101], vcc
    v_dot2c_f32_bf16 v48, v64, v40
    v_dot2c_f32_bf16 v49, v64, v32
    v_dot2c_f32_bf16 v50, v65, v40
    v_dot2c_f32_bf16 v51, v65, v32
    v_dot2c_f32_bf16 v52, v66, v40
    v_dot2c_f32_bf16 v53, v66, v32
    v_dot2c_f32_bf16 v54, v67, v40
    v_dot2c_f32_bf16 v55, v67, v32
L_ops0:
    s_mov_b64 exec, s[6:7]
    s_cbranch_execz L_ops1
    v_xor_b32 v17, s40, v68
    v_bitop3_b32 v17, v69, s41, v17 bitop3:0xbe
    v_bitop3_b32 v17, v70, s42, v17 bitop3:0xbe
    v_bitop3_b32 v17, v71, s43, v17 bitop3:0xbe
    v_and_b32 v17, 0x10001, v17
    v_cmp_ne_u32 vcc, 0, v17
    s_wqm_b64 s[6:7], vcc
    s_andn2_b64 exec, exec, s[6:7]
    s_or_b64 s[100:101], s[100:101], vcc
    v_dot2c_f32_bf16 v48, v68, v41
    v_dot2c_f32_bf16 v49, v68, v33
    v_dot2c_f32_bf16 v50, v69, v41
    v_dot2c_f32_bf16 v51, v69, v33
    v_dot2c_f32_bf16 v52, v70, v41
    v_dot2c_f32_bf16 v53, v70, v33
    v_dot2c_f32_bf16 v54, v71, v41
    v_dot2c_f32_bf16 v55, v71, v33
L_ops1:
    s_mov_b64 exec, s[8:9]
    s_cbranch_execz L_ops2
    v_xor_b32 v17, s40, v72
    v_bitop3_b32 v17, v73, s41, v17 bitop3:0xbe
    v_bitop3_b32 v17, v74, s42, v17 bitop3:0xbe
    v_bitop3_b32 v17, v75, s43, v17 bitop3:0xbe
    v_and_b32 v17, 0x10001, v17
    v_cmp_ne_u32 vcc, 0, v17
    s_wqm_b64 s[8:9], vcc
    s_andn2_b64 exec, exec, s[8:9]
    s_or_b64 s[100:101], s[100:101], vcc
    v_dot2c_f32_bf16 v48, v72, v42
    v_dot2c_f32_bf16 v49, v72, v34
    v_dot2c_f32_bf16 v50, v73, v42
    v_dot2c_f32_bf16 v51, v73, v34
    v_dot2c_f32_bf16 v52, v74, v42
    v_dot2c_f32_bf16 v53, v74, v34
    v_dot2c_f32_bf16 v54, v75, v42
    v_dot2c_f32_bf16 v55, v75, v34
L_ops2:
    s_mov_b64 exec, s[10:11]
    s_cbranch_execz L_ops3
    v_xor_b32 v17, s40, v76
    v_bitop3_b32 v17, v77, s41, v17 bitop3:0xbe
    v_bitop3_b32 v17, v78, s42, v17 bitop3:0xbe
    v_bitop3_b32 v17, v79, s43, v17 bitop3:0xbe
    v_and_b32 v17, 0x10001, v17
    v_cmp_ne_u32 vcc, 0, v17
    s_wqm_b64 s[10:11], vcc
    s_andn2_b64 exec, exec, s[10:11]
    s_or_b64 s[100:101], s[100:101], vcc
    v_dot2c_f32_bf16 v48, v76, v43
    v_dot2c_f32_bf16 v49, v76, v35
    v_dot2c_f32_bf16 v50, v77, v43
    v_dot2c_f32_bf16 v51, v77, v35
    v_dot2c_f32_bf16 v52, v78, v43
    v_dot2c_f32_bf16 v53, v78, v35
    v_dot2c_f32_bf16 v54, v79, v43
    v_dot2c_f32_bf16 v55, v79, v35
L_ops3:
    s_mov_b64 exec, s[12:13]
    s_cbranch_execz L_ops4
    v_xor_b32 v17, s40, v80
    v_bitop3_b32 v17, v81, s41, v17 bitop3:0xbe
    v_bitop3_b32 v17, v82, s42, v17 bitop3:0xbe
    v_bitop3_b32 v17, v83, s43, v17 bitop3:0xbe
    v_and_b32 v17, 0x10001, v17
    v_cmp_ne_u32 vcc, 0, v17
    s_wqm_b64 s[12:13], vcc
    s_andn2_b64 exec, exec, s[12:13]
    s_or_b64 s[100:101], s[100:101], vcc
    v_dot2c_f32_bf16 v48, v80, v44
    v_dot2c_f32_bf16 v49, v80, v36
    v_dot2c_f32_bf16 v50, v81, v44
    v_dot2c_f32_bf16 v51, v81, v36
    v_dot2c_f32_bf16 v52, v82, v44
    v_dot2c_f32_bf16 v53, v82, v36
    v_dot2c_f32_bf16 v54, v83, v44
    v_dot2c_f32_bf16 v55, v83, v36
L_ops4:
    s_mov_b64 exec, s[14:15]
    s_cbranch_execz L_ops5
    v_xor_b32 v17, s40, v84
    v_bitop3_b32 v17, v85, s41, v17 bitop3:0xbe
    v_bitop3_b32 v17, v86, s42, v17 bitop3:0xbe
    v_bitop3_b32 v17, v87, s43, v17 bitop3:0xbe
    v_and_b32 v17, 0x10001, v17
    v_cmp_ne_u32 vcc, 0, v17
    s_wqm_b64 s[14:15], vcc
    s_andn2_b64 exec, exec, s[14:15]
    s_or_b64 s[100:101], s[100:101], vcc
    v_dot2c_f32_bf16 v48, v84, v45
    v_dot2c_f32_bf16 v49, v84, v37
    v_dot2c_f32_bf16 v50, v85, v45
    v_dot2c_f32_bf16 v51, v85, v37
    v_dot2c_f32_bf16 v52, v86, v45
    v_dot2c_f32_bf16 v53, v86, v37
    v_dot2c_f32_bf16 v54, v87, v45
    v_dot2c_f32_bf16 v55, v87, v37
L_ops5:
    s_mov_b64 exec, s[16:17]
    s_cbranch_execz L_ops6
    v_xor_b32 v17, s40, v88
    v_bitop3_b32 v17, v89, s41, v17 bitop3:0xbe
    v_bitop3_b32 v17, v90, s42, v17 bitop3:0xbe
    v_bitop3_b32 v17, v91, s43, v17 bitop3:0xbe
    v_and_b32 v17, 0x10001, v17
    v_cmp_ne_u32 vcc, 0, v17
    s_wqm_b64 s[16:17], vcc
    s_andn2_b64 exec, exec, s[16:17]
    s_or_b64 s[100:101], s[100:101], vcc
    v_dot2c_f32_bf16 v48, v88, v46
    v_dot2c_f32_bf16 v49, v88, v38
    v_dot2c_f32_bf16 v50, v89, v46
    v_dot2c_f32_bf16 v51, v89, v38
    v_dot2c_f32_bf16 v52, v90, v46
    v_dot2c_f32_bf16 v53, v90, v38
    v_dot2c_f32_bf16 v54, v91, v46
    v_dot2c_f32_bf16 v55, v91, v38
L_ops6:
    s_mov_b64 exec, s[18:19]
    s_cbranch_execz L_ops7
    v_xor_b32 v17, s40, v92
    v_bitop3_b32 v17, v93, s41, v17 bitop3:0xbe
    v_bitop3_b32 v17, v94, s42, v17 bitop3:0xbe
    v_bitop3_b32 v17, v95, s43, v17 bitop3:0xbe
    v_and_b32 v17, 0x10001, v17
    v_cmp_ne_u32 vcc, 0, v17
    s_wqm_b64 s[18:19], vcc
    s_andn2_b64 exec, exec, s[18:19]
    s_or_b64 s[100:101], s[100:101], vcc
    v_dot2c_f32_bf16 v48, v92, v47
    v_dot2c_f32_bf16 v49, v92, v39
    v_dot2c_f32_bf16 v50, v93, v47
    v_dot2c_f32_bf16 v51, v93, v39
    v_dot2c_f32_bf16 v52, v94, v47
    v_dot2c_f32_bf16 v53, v94, v39
    v_dot2c_f32_bf16 v54, v95, v47
    v_dot2c_f32_bf16 v55, v95, v39
L_ops7:
    s_branch L_ope
L_op2:
    s_waitcnt vmcnt(7)
    v_xor_b32 v17, s40, v64
    v_bitop3_b32 v17, v65, s41, v17 bitop3:0xbe
    v_bitop3_b32 v17, v66, s42, v17 bitop3:0xbe
    v_bitop3_b32 v17, v67, s43, v17 bitop3:0xbe
    v_and_b32 v17, 0x10001, v17
    v_cmp_ne_u32 vcc, 0, v17
    s_wqm_b64 s[4:5], vcc
    s_andn2_b64 exec, exec, s[4:5]
    s_or_b64 s[100:101], s[100:101], vcc
    v_dot2c_f32_bf16 v48, v64, v40
    v_dot2c_f32_bf16 v49, v64, v32
    v_dot2c_f32_bf16 v50, v65, v40
    v_dot2c_f32_bf16 v51, v65, v32
    v_dot2c_f32_bf16 v52, v66, v40
    v_dot2c_f32_bf16 v53, v66, v32
    v_dot2c_f32_bf16 v54, v67, v40
    v_dot2c_f32_bf16 v55, v67, v32
    s_mov_b64 exec, -1
    s_waitcnt vmcnt(6)
    v_xor_b32 v17, s40, v68
    v_bitop3_b32 v17, v69, s41, v17 bitop3:0xbe
    v_bitop3_b32 v17, v70, s42, v17 bitop3:0xbe
    v_bitop3_b32 v17, v71, s43, v17 bitop3:0xbe
    v_and_b32 v17, 0x10001, v17
    v_cmp_ne_u32 vcc, 0, v17
    s_wqm_b64 s[6:7], vcc
    s_andn2_b64 exec, exec, s[6:7]
    s_or_b64 s[100:101], s[100:101], vcc
    v_dot2c_f32_bf16 v48, v68, v41
    v_dot2c_f32_bf16 v49, v68, v33
    v_dot2c_f32_bf16 v50, v69, v41
    v_dot2c_f32_bf16 v51, v69, v33
    v_dot2c_f32_bf16 v52, v70, v41
    v_dot2c_f32_bf16 v53, v70, v33
    v_dot2c_f32_bf16 v54, v71, v41
    v_dot2c_f32_bf16 v55, v71, v33
    s_mov_b64 exec, -1
    s_waitcnt vmcnt(5)
    v_xor_b32 v17, s40, v72
    v_bitop3_b32 v17, v73, s41, v17 bitop3:0xbe
    v_bitop3_b32 v17, v74, s42, v17 bitop3:0xbe
    v_bitop3_b32 v17, v75, s43, v17 bitop3:0xbe
    v_and_b32 v17, 0x10001, v17
    v_cmp_ne_u32 vcc, 0, v17
    s_wqm_b64 s[8:9], vcc
    s_andn2_b64 exec, exec, s[8:9]
    s_or_b64 s[100:101], s[100:101], vcc
    v_dot2c_f32_bf16 v48, v72, v42
    v_dot2c_f32_bf16 v49, v72, v34
    v_dot2c_f32_bf16 v50, v73, v42
    v_dot2c_f32_bf16 v51, v73, v34
    v_dot2c_f32_bf16 v52, v74, v42
    v_dot2c_f32_bf16 v53, v74, v34
    v_dot2c_f32_bf16 v54, v75, v42
    v_dot2c_f32_bf16 v55, v75, v34
    s_mov_b64 exec, -1
    s_waitcnt vmcnt(4)
    v_xor_b32 v17, s40, v76
    v_bitop3_b32 v17, v77, s41, v17 bitop3:0xbe
    v_bitop3_b32 v17, v78, s42, v17 bitop3:0xbe
    v_bitop3_b32 v17, v79, s43, v17 bitop3:0xbe
    v_and_b32 v17, 0x10001, v17
    v_cmp_ne_u32 vcc, 0, v17
    s_wqm_b64 s[10:11], vcc
    s_andn2_b64 exec, exec, s[10:11]
    s_or_b64 s[100:101], s[100:101], vcc
    v_dot2c_f32_bf16 v48, v76, v43
    v_dot2c_f32_bf16 v49, v76, v35
    v_dot2c_f32_bf16 v50, v77, v43
    v_dot2c_f32_bf16 v51, v77, v35
    v_dot2c_f32_bf16 v52, v78, v43
    v_dot2c_f32_bf16 v53, v78, v35
    v_dot2c_f32_bf16 v54, v79, v43
    v_dot2c_f32_bf16 v55, v79, v35
    s_mov_b64 exec, -1
    s_waitcnt vmcnt(3)
    v_xor_b32 v17, s40, v80
    v_bitop3_b32 v17, v81, s41, v17 bitop3:0xbe
    v_bitop3_b32 v17, v82, s42, v17 bitop3:0xbe
    v_bitop3_b32 v17, v83, s43, v17 bitop3:0xbe
    v_and_b32 v17, 0x10001, v17
    v_cmp_ne_u32 vcc, 0, v17
    s_wqm_b64 s[12:13], vcc
    s_andn2_b64 exec, exec, s[12:13]
    s_or_b64 s[100:101], s[100:101], vcc
    v_dot2c_f32_bf16 v48, v80, v44
    v_dot2c_f32_bf16 v49, v80, v36
    v_dot2c_f32_bf16 v50, v81, v44
    v_dot2c_f32_bf16 v51, v81, v36
    v_dot2c_f32_bf16 v52, v82, v44
    v_dot2c_f32_bf16 v53, v82, v36
    v_dot2c_f32_bf16 v54, v83, v44
    v_dot2c_f32_bf16 v55, v83, v36
    s_mov_b64 exec, -1
    s_waitcnt vmcnt(2)
    v_xor_b32 v17, s40, v84
    v_bitop3_b32 v17, v85, s41, v17 bitop3:0xbe
    v_bitop3_b32 v17, v86, s42, v17 bitop3:0xbe
    v_bitop3_b32 v17, v87, s43, v17 bitop3:0xbe
    v_and_b32 v17, 0x10001, v17
    v_cmp_ne_u32 vcc, 0, v17
    s_wqm_b64 s[14:15], vcc
    s_andn2_b64 exec, exec, s[14:15]
    s_or_b64 s[100:101], s[100:101], vcc
    v_dot2c_f32_bf16 v48, v84, v45
    v_dot2c_f32_bf16 v49, v84, v37
    v_dot2c_f32_bf16 v50, v85, v45
    v_dot2c_f32_bf16 v51, v85, v37
    v_dot2c_f32_bf16 v52, v86, v45
    v_dot2c_f32_bf16 v53, v86, v37
    v_dot2c_f32_bf16 v54, v87, v45
    v_dot2c_f32_bf16 v55, v87, v37
    s_mov_b64 exec, -1
    s_waitcnt vmcnt(1)
    v_xor_b32 v17, s40, v88
    v_bitop3_b32 v17, v89, s41, v17 bitop3:0xbe
    v_bitop3_b32 v17, v90, s42, v17 bitop3:0xbe
    v_bitop3_b32 v17, v91, s43, v17 bitop3:0xbe
    v_and_b32 v17, 0x10001, v17
    v_cmp_ne_u32 vcc, 0, v17
    s_wqm_b64 s[16:17], vcc
    s_andn2_b64 exec, exec, s[16:17]
    s_or_b64 s[100:101], s[100:101], vcc
    v_dot2c_f32_bf16 v48, v88, v46
    v_dot2c_f32_bf16 v49, v88, v38
    v_dot2c_f32_bf16 v50, v89, v46
    v_dot2c_f32_bf16 v51, v89, v38
    v_dot2c_f32_bf16 v52, v90, v46
    v_dot2c_f32_bf16 v53, v90, v38
    v_dot2c_f32_bf16 v54, v91, v46
    v_dot2c_f32_bf16 v55, v91, v38
    s_mov_b64 exec, -1
    s_waitcnt vmcnt(0)
    v_xor_b32 v17, s40, v92
    v_bitop3_b32 v17, v93, s41, v17 bitop3:0xbe
    v_bitop3_b32 v17, v94, s42, v17 bitop3:0xbe
    v_bitop3_b32 v17, v95, s43, v17 bitop3:0xbe
    v_and_b32 v17, 0x10001, v17
    v_cmp_ne_u32 vcc, 0, v17
    s_wqm_b64 s[18:19], vcc
    s_andn2_b64 exec, exec, s[18:19]
    s_or_b64 s[100:101], s[100:101], vcc
    v_dot2c_f32_bf16 v48, v92, v47
    v_dot2c_f32_bf16 v49, v92, v39
    v_dot2c_f32_bf16 v50, v93, v47
    v_dot2c_f32_bf16 v51, v93, v39
    v_dot2c_f32_bf16 v52, v94, v47
    v_dot2c_f32_bf16 v53, v94, v39
    v_dot2c_f32_bf16 v54, v95, v47
    v_dot2c_f32_bf16 v55, v95, v39
    s_mov_b64 exec, -1
    s_branch L_ope
L_m2:
    buffer_load_dword v24, v22, s[48:51], s74 offen sc1
    buffer_load_dword v25, v21, s[48:51], s74 offen sc1
    buffer_load_dword v28, v22, s[48:51], s75 offen sc1
    buffer_load_dword v30, v21, s[48:51], s75 offen sc1
    buffer_load_dword v29, v22, s[48:51], s26 offen sc1
    buffer_load_dword v31, v21, s[48:51], s26 offen sc1
    s_add_u32 s96, s96, 1
    s_cmp_ge_u32 s96, 40000
    s_cbranch_scc1 L_done
    s_waitcnt vmcnt(0)
    s_branch L_m2b
L_cpg:
    s_mov_b64 exec, 0x01010101
    buffer_store_dwordx4 v[12:15], v20, s[48:51], s71 offen sc1
    s_mov_b64 exec, -1
    s_add_u32 s68, s68, 65536
    s_branch L_cpb
L_nE2:
    buffer_store_dwordx4 v[12:15], v20, s[48:51], s71 offen sc1
    s_mov_b64 exec, -1
    s_cmp_ge_u32 s37, 14
    s_cbranch_scc1 L_xf
    s_sub_u32 s97, s37, 9
    s_lshl3_add_u32 s97, s97, s36
    s_cmp_ge_u32 s97, 36
    s_cbranch_scc1 L_done
    s_cmp_lg_u32 s35, 0
    s_cbranch_scc1 L_done
    s_mov_b64 s[64:65], s[28:29]
    s_mov_b32 s66, 1152
    s_mov_b32 s67, 0x20000
    s_mul_i32 s68, s97, 7282
    s_lshr_b32 s68, s68, 16
    s_mul_i32 s69, s68, 9
    s_sub_u32 s69, s97, s69
    s_mul_i32 s68, s68, 144
    s_lshr_b32 s70, s69, 2
    s_lshl_b32 s70, s70, 6
    s_add_u32 s68, s68, s70
    s_and_b32 s70, s69, 3
    s_lshl2_add_u32 s68, s70, s68
    s_cmp_eq_u32 s69, 8
    s_cselect_b32 s70, 4, 1
    s_cselect_b32 s71, 1, 16
    v_and_b32 v8, 3, v1
    v_mul_u32_u24 v9, s70, v8
    v_mul_u32_u24 v8, s71, v2
    v_add3_u32 v9, v9, v8, s68
    v_lshlrev_b32 v10, 2, v9
    v_lshlrev_b32 v9, 1, v9
    v_lshrrev_b32 v11, 2, v3
    v_mul_u32_u24 v11, 2304, v11
    v_add_u32 v11, v11, v10
    s_mov_b32 s72, 299008
    s_mov_b32 s73, 308224
    s_mov_b32 s74, 236288
    s_mov_b32 s75, 245504
    s_mov_b32 s71, 254720
    s_mul_i32 s68, s97, 9216
    s_add_u32 s68, s68, 327680
    s_add_u32 s69, s68, 4096
    s_add_u32 s70, s68, 8192
L_t32:
    buffer_load_dword v24, v11, s[48:51], s72 offen sc1
    buffer_load_dword v25, v11, s[48:51], s73 offen sc1
    buffer_load_dword v26, v10, s[48:51], s74 offen sc1
    buffer_load_dword v27, v10, s[48:51], s75 offen sc1
    buffer_load_dword v28, v10, s[48:51], s71 offen sc1
    s_add_u32 s96, s96, 1
    s_cmp_ge_u32 s96, 40000
    s_cbranch_scc1 L_done
    s_waitcnt vmcnt(0)
    v_xor_b32 v15, s39, v24
    v_bitop3_b32 v15, v25, s39, v15 bitop3:0xbe
    v_bitop3_b32 v15, v26, s39, v15 bitop3:0xbe
    v_bitop3_b32 v15, v27, s39, v15 bitop3:0xbe
    v_bitop3_b32 v15, v28, s39, v15 bitop3:0xbe
    v_and_b32 v15, 0xff, v15
    v_cmp_ne_u32 vcc, 0, v15
    s_cbranch_vccnz L_t32
    v_add_f32 v24, v24, v25
    s_nop 1
    v_add_f32_dpp v24, v24, v24 row_ror:4 row_mask:0xf bank_mask:0xf
    s_nop 1
    v_add_f32_dpp v24, v24, v24 row_ror:8 row_mask:0xf bank_mask:0xf
    v_add_f32 v26, v26, v27
    v_add_f32 v26, v26, v28
    v_cvt_pk_bf16_f32 v24, v24, v24
    v_and_b32 v24, 0xffff0000, v24
    v_cvt_pk_bf16_f32 v26, v26, v26
    v_and_b32 v26, 0xffff0000, v26
L_yp:
    buffer_load_dwordx4 v[64:67], v4, s[48:51], s68 offen sc1
    buffer_load_dwordx4 v[68:71], v4, s[48:51], s68 offen offset:1024 sc1
    buffer_load_dwordx4 v[72:75], v4, s[48:51], s68 offen offset:2048 sc1
    buffer_load_dwordx4 v[76:79], v4, s[48:51], s68 offen offset:3072 sc1
    buffer_load_dwordx4 v[80:83], v4, s[48:51], s69 offen sc1
    buffer_load_dwordx4 v[84:87], v4, s[48:51], s69 offen offset:1024 sc1
    buffer_load_dwordx4 v[88:91], v4, s[48:51], s69 offen offset:2048 sc1
    buffer_load_dwordx4 v[92:95], v4, s[48:51], s69 offen offset:3072 sc1
    buffer_load_dwordx4 v[96:99], v4, s[48:51], s70 offen sc1
    s_mov_b64 exec, -1
    s_add_u32 s96, s96, 1
    s_cmp_ge_u32 s96, 40000
    s_cbranch_scc1 L_done
    s_waitcnt vmcnt(0)
    v_xor_b32 v15, s39, v64
    v_bitop3_b32 v15, v68, s39, v15 bitop3:0xbe
    v_bitop3_b32 v15, v72, s39, v15 bitop3:0xbe
    v_bitop3_b32 v15, v76, s39, v15 bitop3:0xbe
    v_bitop3_b32 v15, v80, s39, v15 bitop3:0xbe
    v_bitop3_b32 v15, v84, s39, v15 bitop3:0xbe
    v_bitop3_b32 v15, v88, s39, v15 bitop3:0xbe
    v_bitop3_b32 v15, v92, s39, v15 bitop3:0xbe
    v_bitop3_b32 v15, v96, s39, v15 bitop3:0xbe
    v_and_b32 v15, 0xff, v15
    v_cmp_ne_u32 vcc, 0, v15
    s_wqm_b64 exec, vcc
    s_cbranch_execnz L_yp
    s_mov_b64 exec, -1
    v_pk_add_f32 v[64:65], v[64:65], v[68:69]
    v_pk_add_f32 v[66:67], v[66:67], v[70:71]
    v_pk_add_f32 v[72:73], v[72:73], v[76:77]
    v_pk_add_f32 v[74:75], v[74:75], v[78:79]
    v_pk_add_f32 v[80:81], v[80:81], v[84:85]
    v_pk_add_f32 v[82:83], v[82:83], v[86:87]
    v_pk_add_f32 v[88:89], v[88:89], v[92:93]
    v_pk_add_f32 v[90:91], v[90:91], v[94:95]
    v_pk_add_f32 v[64:65], v[64:65], v[96:97]
    v_pk_add_f32 v[66:67], v[66:67], v[98:99]
    v_pk_add_f32 v[72:73], v[72:73], v[80:81]
    v_pk_add_f32 v[74:75], v[74:75], v[82:83]
    v_pk_add_f32 v[64:65], v[64:65], v[88:89]
    v_pk_add_f32 v[66:67], v[66:67], v[90:91]
    v_pk_add_f32 v[64:65], v[64:65], v[72:73]
    v_pk_add_f32 v[66:67], v[66:67], v[74:75]
    s_nop 1
    v_permlane32_swap_b32 v64, v66
    v_permlane32_swap_b32 v65, v67
    v_add_f32 v64, v64, v66
    v_add_f32 v65, v65, v67
    s_nop 1
    v_permlane16_swap_b32 v64, v65
    v_add_f32 v64, v64, v65
    s_nop 1
    v_add_f32_dpp v64, v64, v64 row_ror:4 row_mask:0xf bank_mask:0xf
    s_nop 1
    v_add_f32_dpp v64, v64, v64 row_ror:8 row_mask:0xf bank_mask:0xf
    v_cvt_pk_bf16_f32 v64, v64, v64
    v_and_b32 v64, 0xffff0000, v64
    v_mul_f32 v64, v64, v26
    v_cvt_pk_bf16_f32 v64, v64, v64
    v_and_b32 v64, 0xffff0000, v64
    v_add_f32 v64, v64, v24
    v_cvt_pk_bf16_f32 v64, v64, v64
    s_mov_b32 exec_lo, 0xf000f
    s_mov_b32 exec_hi, 0xf000f
    buffer_store_short v64, v9, s[64:67], 0 offen
    s_cmp_lg_u32 s97, 0
    s_cbranch_scc1 L_done
    s_mov_b64 exec, 1
    v_mov_b32 v8, 0
    v_mov_b32 v9, s34
    buffer_store_dword v9, v8, s[48:51], 0 offen sc1
    s_branch L_done
L_Y:
    v_lshlrev_b32 v19, 1, v2
    v_xor_b32 v18, v19, v3
    v_lshlrev_b32 v18, 4, v18
    v_mov_b32 v19, 8192
    v_mad_u32_u24 v18, v2, v19, v18
    s_lshr_b32 s98, s37, 2
    s_lshl2_add_u32 s44, s36, s98
    s_and_b32 s45, s37, 3
    s_lshl2_add_u32 s98, s36, s35
    s_lshl4_add_u32 s98, s98, s37
    s_lshl_b32 s98, s98, 6
    s_mul_i32 s68, s45, 1179648
    s_lshl_b32 s69, s44, 8
    s_add_u32 s68, s68, s69
    s_lshl_b32 s69, s35, 18
    s_add_u32 s69, s69, s68
    s_mul_i32 s70, s35, 9216
    v_lshlrev_b32 v20, 2, v1
    v_min_u32 v9, 35, v1
    s_mul_i32 s72, s35, 36
    v_add_u32 v9, s72, v9
    s_mul_i32 s72, s45, 144
    v_add_u32 v10, s72, v9
    v_lshlrev_b32 v11, 1, v10
    s_waitcnt lgkmcnt(0)
    s_load_dword s34, s[32:33], 0
    s_mov_b64 s[52:53], s[8:9]
    s_mov_b32 s54, 4718592
    s_mov_b32 s55, 0x20000
    s_mov_b64 s[60:61], s[4:5]
    s_mov_b32 s62, 1152
    s_mov_b32 s63, 0x20000
    s_add_u32 s71, s69, 0
    s_add_u32 m0, s70, 0
    s_nop 0
    buffer_load_dwordx4 v18, s[52:55], s71 offen nt lds
    buffer_load_dwordx4 v[12:15], v4, s[60:63], 0 offen
    buffer_load_dword v16, v20, s[60:63], 0 offen offset:1024
    buffer_load_ushort v17, v11, s[60:63], 0 offen
    s_add_u32 s71, s69, 65536
    s_add_u32 m0, s70, 1152
    s_nop 0
    buffer_load_dwordx4 v18, s[52:55], s71 offen nt lds
    s_add_u32 s71, s69, 131072
    s_add_u32 m0, s70, 2304
    s_nop 0
    buffer_load_dwordx4 v18, s[52:55], s71 offen nt lds
    s_add_u32 s71, s69, 196608
    s_add_u32 m0, s70, 3456
    s_nop 0
    buffer_load_dwordx4 v18, s[52:55], s71 offen nt lds
    s_add_u32 s71, s69, 32768
    s_add_u32 m0, s70, 4608
    s_nop 0
    buffer_load_dwordx4 v18, s[52:55], s71 offen nt lds
    s_add_u32 s71, s69, 98304
    s_add_u32 m0, s70, 5760
    s_nop 0
    buffer_load_dwordx4 v18, s[52:55], s71 offen nt lds
    s_add_u32 s71, s69, 163840
    s_add_u32 m0, s70, 6912
    s_nop 0
    buffer_load_dwordx4 v18, s[52:55], s71 offen nt lds
    s_add_u32 s71, s69, 229376
    s_add_u32 m0, s70, 8064
    s_nop 0
    buffer_load_dwordx4 v18, s[52:55], s71 offen nt lds
    s_lshl_b32 s71, s35, 15
    s_add_u32 s71, s71, s68
    s_add_u32 s71, s71, 1048576
    s_mul_i32 s72, s35, 1152
    s_add_u32 m0, s72, 36864
    s_nop 0
    buffer_load_dwordx4 v18, s[52:55], s71 offen nt lds
    s_mov_b64 s[56:57], s[10:11]
    s_mov_b32 s58, 4194304
    s_mov_b32 s59, 0x20000
    s_lshl_b32 s68, s37, 18
    s_lshl_b32 s69, s35, 16
    s_add_u32 s68, s68, s69
    s_lshl_b32 s69, s36, 10
    s_add_u32 s68, s68, s69
    s_mul_i32 s70, s35, 8320
    s_mov_b32 s46, s68
    s_mov_b32 s38, s70
    s_add_u32 s97, s46, 0
    s_add_u32 m0, s38, 41472
    s_nop 0
    buffer_load_dwordx4 v4, s[56:59], s97 offen nt lds
    s_add_u32 s97, s46, 8192
    s_add_u32 m0, s38, 42512
    s_nop 0
    buffer_load_dwordx4 v4, s[56:59], s97 offen nt lds
    s_add_u32 s97, s46, 16384
    s_add_u32 m0, s38, 43552
    s_nop 0
    buffer_load_dwordx4 v4, s[56:59], s97 offen nt lds
    s_add_u32 s97, s46, 24576
    s_add_u32 m0, s38, 44592
    s_nop 0
    buffer_load_dwordx4 v4, s[56:59], s97 offen nt lds
    s_add_u32 s97, s46, 32768
    s_add_u32 m0, s38, 45632
    s_nop 0
    buffer_load_dwordx4 v4, s[56:59], s97 offen nt lds
    s_add_u32 s97, s46, 40960
    s_add_u32 m0, s38, 46672
    s_nop 0
    buffer_load_dwordx4 v4, s[56:59], s97 offen nt lds
    s_add_u32 s97, s46, 49152
    s_add_u32 m0, s38, 47712
    s_nop 0
    buffer_load_dwordx4 v4, s[56:59], s97 offen nt lds
    s_add_u32 s97, s46, 57344
    s_add_u32 m0, s38, 48752
    s_nop 0
    buffer_load_dwordx4 v4, s[56:59], s97 offen nt lds
    v_mov_b32 v5, 0xfffefffe
    v_mov_b32 v6, 0xffffff00
    v_and_b32 v7, 6, v1
    s_waitcnt lgkmcnt(0)
    s_add_u32 s34, s34, 1
    s_and_b32 s39, s34, 0xff
    s_mul_i32 s43, s39, 0x8001
    v_lshrrev_b32 v7, v7, s43
    v_and_b32 v7, 0x10001, v7
    s_and_b32 s40, s43, 0x10001
    s_lshr_b32 s41, s43, 2
    s_and_b32 s41, s41, 0x10001
    s_lshr_b32 s42, s43, 4
    s_and_b32 s42, s42, 0x10001
    s_lshr_b32 s43, s43, 6
    s_and_b32 s43, s43, 0x10001
    s_mov_b64 s[48:49], s[32:33]
    s_mov_b32 s50, 6815744
    s_mov_b32 s51, 0x20000
    v_lshlrev_b32 v10, 2, v10
    s_mov_b32 s73, 4096
    s_mov_b32 s74, 8704
    s_mov_b32 s75, 13312
    s_waitcnt vmcnt(16)
    v_mov_b32 v20, 0
    v_mov_b32 v21, 0
    v_lshlrev_b32 v22, 16, v12
    v_and_b32 v23, 0xffff0000, v12
    v_add_f32 v20, v20, v22
    v_fmac_f32 v21, v22, v22
    v_add_f32 v20, v20, v23
    v_fmac_f32 v21, v23, v23
    v_lshlrev_b32 v22, 16, v13
    v_and_b32 v23, 0xffff0000, v13
    v_add_f32 v20, v20, v22
    v_fmac_f32 v21, v22, v22
    v_add_f32 v20, v20, v23
    v_fmac_f32 v21, v23, v23
    v_lshlrev_b32 v22, 16, v14
    v_and_b32 v23, 0xffff0000, v14
    v_add_f32 v20, v20, v22
    v_fmac_f32 v21, v22, v22
    v_add_f32 v20, v20, v23
    v_fmac_f32 v21, v23, v23
    v_lshlrev_b32 v22, 16, v15
    v_and_b32 v23, 0xffff0000, v15
    v_add_f32 v20, v20, v22
    v_fmac_f32 v21, v22, v22
    v_add_f32 v20, v20, v23
    v_fmac_f32 v21, v23, v23
    v_lshlrev_b32 v22, 16, v16
    v_and_b32 v23, 0xffff0000, v16
    v_add_f32 v20, v20, v22
    v_fmac_f32 v21, v22, v22
    v_add_f32 v20, v20, v23
    v_fmac_f32 v21, v23, v23
    s_nop 0
    v_add_f32_dpp v20, v20, v20 row_ror:8 row_mask:0xf bank_mask:0xf
    s_nop 1
    v_add_f32_dpp v20, v20, v20 row_ror:4 row_mask:0xf bank_mask:0xf
    s_nop 1
    v_add_f32_dpp v20, v20, v20 row_ror:2 row_mask:0xf bank_mask:0xf
    s_nop 1
    v_add_f32_dpp v20, v20, v20 row_ror:1 row_mask:0xf bank_mask:0xf
    v_mov_b32 v22, v20
    s_nop 1
    v_permlane16_swap_b32 v20, v22
    v_add_f32 v20, v20, v22
    v_mov_b32 v22, v20
    s_nop 1
    v_permlane32_swap_b32 v20, v22
    v_add_f32 v20, v20, v22
    v_add_f32_dpp v21, v21, v21 row_ror:8 row_mask:0xf bank_mask:0xf
    s_nop 1
    v_add_f32_dpp v21, v21, v21 row_ror:4 row_mask:0xf bank_mask:0xf
    s_nop 1
    v_add_f32_dpp v21, v21, v21 row_ror:2 row_mask:0xf bank_mask:0xf
    s_nop 1
    v_add_f32_dpp v21, v21, v21 row_ror:1 row_mask:0xf bank_mask:0xf
    v_mov_b32 v22, v21
    s_nop 1
    v_permlane16_swap_b32 v21, v22
    v_add_f32 v21, v21, v22
    v_mov_b32 v22, v21
    s_nop 1
    v_permlane32_swap_b32 v21, v22
    v_add_f32 v21, v21, v22
    v_mul_f32 v20, 0x3ae38e39, v20
    v_mul_f32 v21, 0x3ae38e39, v21
    v_fma_f32 v21, -v20, v20, v21
    v_cvt_pk_bf16_f32 v20, v20, v20
    v_and_b32 v20, 0xffff0000, v20
    v_cvt_pk_bf16_f32 v21, v21, v21
    v_and_b32 v21, 0xffff0000, v21
    v_add_f32 v21, 0x3727c5ac, v21
    v_cvt_pk_bf16_f32 v21, v21, v21
    v_and_b32 v21, 0xffff0000, v21
    v_sqrt_f32 v21, v21
    s_nop 0
    v_cvt_pk_bf16_f32 v21, v21, v21
    v_and_b32 v21, 0xffff0000, v21
    v_rcp_f32 v21, v21
    v_lshlrev_b32 v17, 16, v17
    v_sub_f32 v17, v17, v20
    v_cvt_pk_bf16_f32 v17, v17, v17
    v_and_b32 v17, 0xffff0000, v17
    v_mul_f32 v17, v17, v21
    v_cvt_pk_bf16_f32 v17, v17, v17
    v_and_b32 v17, 0xffff0000, v17
    buffer_load_dword v24, v10, s[48:51], s73 offen sc1
    buffer_load_dword v27, v10, s[48:51], s73 offen offset:2304 sc1
    buffer_load_dword v25, v10, s[48:51], s74 offen sc1
    buffer_load_dword v28, v10, s[48:51], s74 offen offset:2304 sc1
    buffer_load_dword v26, v10, s[48:51], s75 offen sc1
    buffer_load_dword v29, v10, s[48:51], s75 offen offset:2304 sc1
    s_lshl_b32 s68, s35, 1
    v_lshrrev_b32 v22, 2, v3
    v_mul_u32_u24 v20, 1152, v2
    v_lshl_add_u32 v20, v22, 8, v20
    v_xor_b32 v22, s68, v22
    v_lshl_add_u32 v20, v22, 5, v20
    v_and_b32 v22, 3, v1
    v_lshl_add_u32 v20, v22, 3, v20
    v_xor_b32 v21, 32, v20
    v_lshlrev_b32 v9, 1, v9
    v_add_u32 v9, 153600, v9
    v_lshlrev_b32 v11, 4, v2
    v_add_u32 v18, 153600, v11
    v_lshlrev_b32 v19, 3, v2
    v_lshl_add_u32 v8, v3, 6, v11
    v_and_b32 v22, 7, v3
    v_mul_u32_u24 v22, 1040, v22
    v_add_u32 v22, v22, v19
    v_lshrrev_b32 v23, 3, v3
    v_lshl_add_u32 v22, v23, 8, v22
    s_add_u32 s70, s70, 41472
    v_add_u32 v22, s70, v22
    v_add_u32 v19, 153856, v19
    s_lshl_b32 s68, s36, 12
    s_add_u32 s68, s68, 32768
    s_add_u32 s69, s98, 32768
    s_add_u32 s70, s98, 163840
    s_lshl3_add_u32 s71, s37, s36
    s_lshl2_add_u32 s71, s71, s35
    s_lshl_b32 s71, s71, 6
    s_add_u32 s71, s71, 65536
    s_mov_b32 s47, 0
    s_mov_b32 s100, 0
    s_mov_b32 s101, -1
    s_waitcnt vmcnt(14)
    s_barrier
    ds_read_b64_tr_b16 a[0:1], v20 offset:0
    ds_read_b64_tr_b16 a[2:3], v20 offset:4608
    ds_read_b64_tr_b16 a[4:5], v20 offset:9216
    ds_read_b64_tr_b16 a[6:7], v20 offset:13824
    ds_read_b64_tr_b16 a[8:9], v20 offset:18432
    ds_read_b64_tr_b16 a[10:11], v20 offset:23040
    ds_read_b64_tr_b16 a[12:13], v20 offset:27648
    ds_read_b64_tr_b16 a[14:15], v20 offset:32256
    ds_read_b64_tr_b16 a[16:17], v20 offset:36864
    ds_read_b64_tr_b16 a[20:21], v21 offset:0
    ds_read_b64_tr_b16 a[22:23], v21 offset:4608
    ds_read_b64_tr_b16 a[24:25], v21 offset:9216
    ds_read_b64_tr_b16 a[26:27], v21 offset:13824
    ds_read_b64_tr_b16 a[28:29], v21 offset:18432
    ds_read_b64_tr_b16 a[30:31], v21 offset:23040
    ds_read_b64_tr_b16 a[32:33], v21 offset:27648
    ds_read_b64_tr_b16 a[34:35], v21 offset:32256
    ds_read_b64_tr_b16 a[36:37], v21 offset:36864
    s_waitcnt vmcnt(6)
    ds_read2_b64 a[64:67], v22 offset0:0 offset1:4
    ds_read2_b64 a[68:71], v22 offset0:8 offset1:12
    ds_read2_b64 a[72:75], v22 offset0:16 offset1:20
    ds_read2_b64 a[76:79], v22 offset0:24 offset1:28
    ds_read2_b64 a[80:83], v22 offset0:64 offset1:68
    ds_read2_b64 a[84:87], v22 offset0:72 offset1:76
    ds_read2_b64 a[88:91], v22 offset0:80 offset1:84
    ds_read2_b64 a[92:95], v22 offset0:88 offset1:92
    s_waitcnt vmcnt(0)
    s_branch L_mb
L_mp:
    buffer_load_dword v24, v10, s[48:51], s73 offen sc1
    buffer_load_dword v27, v10, s[48:51], s73 offen offset:2304 sc1
    buffer_load_dword v25, v10, s[48:51], s74 offen sc1
    buffer_load_dword v28, v10, s[48:51], s74 offen offset:2304 sc1
    buffer_load_dword v26, v10, s[48:51], s75 offen sc1
    buffer_load_dword v29, v10, s[48:51], s75 offen offset:2304 sc1
    s_add_u32 s96, s96, 1
    s_cmp_ge_u32 s96, 40000
    s_cbranch_scc1 L_done
    s_waitcnt vmcnt(0)
L_mb:
    v_xor_b32 v23, s39, v24
    v_bitop3_b32 v23, v25, s39, v23 bitop3:0xbe
    v_bitop3_b32 v23, v26, s39, v23 bitop3:0xbe
    v_bitop3_b32 v23, v27, s39, v23 bitop3:0xbe
    v_bitop3_b32 v23, v28, s39, v23 bitop3:0xbe
    v_bitop3_b32 v23, v29, s39, v23 bitop3:0xbe
    v_and_b32 v23, 0xff, v23
    v_cmp_ne_u32 vcc, 0, v23
    v_add_f32 v30, v24, v25
    v_add_f32 v31, v27, v28
    s_cbranch_vccnz L_mp
    v_add_f32 v31, v31, v29
    v_add_f32 v30, v30, v26
    v_cvt_pk_bf16_f32 v30, v30, v31
    v_and_b32 v31, 0xffff0000, v30
    v_add_f32 v31, 1.0, v31
    v_lshlrev_b32 v30, 16, v30
    v_cvt_pk_bf16_f32 v31, v31, v31
    v_and_b32 v31, 0xffff0000, v31
    v_mul_f32 v31, v31, v17
    v_cvt_pk_bf16_f32 v31, v31, v31
    v_and_b32 v31, 0xffff0000, v31
    v_add_f32 v31, v31, v30
    v_cvt_pk_bf16_f32 v31, v31, v31
    ds_write_b16 v9, v31
    s_waitcnt lgkmcnt(0)
    s_barrier
    ds_read_b128 v[32:35], v18 offset:0
    ds_read_b128 v[36:39], v18 offset:64
    ds_read_b128 v[40:43], v18 offset:128
    ds_read_b128 v[44:47], v18 offset:192
    ds_read_b64 v[48:49], v19
    s_waitcnt lgkmcnt(4)
    v_mfma_f32_16x16x32_bf16 v[52:55], a[0:3], v[32:35], 0
    v_mfma_f32_16x16x32_bf16 v[56:59], a[20:23], v[32:35], 0
    s_waitcnt lgkmcnt(3)
    v_mfma_f32_16x16x32_bf16 v[52:55], a[4:7], v[36:39], v[52:55]
    v_mfma_f32_16x16x32_bf16 v[56:59], a[24:27], v[36:39], v[56:59]
    s_waitcnt lgkmcnt(2)
    v_mfma_f32_16x16x32_bf16 v[52:55], a[8:11], v[40:43], v[52:55]
    v_mfma_f32_16x16x32_bf16 v[56:59], a[28:31], v[40:43], v[56:59]
    s_waitcnt lgkmcnt(1)
    v_mfma_f32_16x16x32_bf16 v[52:55], a[12:15], v[44:47], v[52:55]
    v_mfma_f32_16x16x32_bf16 v[56:59], a[32:35], v[44:47], v[56:59]
    s_waitcnt lgkmcnt(0)
    v_mfma_f32_16x16x16_bf16 v[52:55], a[16:17], v[48:49], v[52:55]
    v_mfma_f32_16x16x16_bf16 v[56:59], a[36:37], v[48:49], v[56:59]
    s_nop 5
    v_cvt_pk_bf16_f32 v12, v52, v53
    v_and_or_b32 v12, v12, v5, s40
    v_cvt_pk_bf16_f32 v13, v54, v55
    v_and_or_b32 v13, v13, v5, s41
    v_cvt_pk_bf16_f32 v14, v56, v57
    v_and_or_b32 v14, v14, v5, s42
    v_cvt_pk_bf16_f32 v15, v58, v59
    v_and_or_b32 v15, v15, v5, s43
    s_mov_b32 exec_lo, 0x10001
    s_mov_b32 exec_hi, 0x10001
    buffer_store_dwordx4 v[12:15], v11, s[48:51], s69 offen
    s_mov_b64 exec, -1
L_qp:
    buffer_load_dwordx4 v[32:35], v8, s[48:51], s68 offen sc1
    buffer_load_dwordx4 v[36:39], v8, s[48:51], s68 offen offset:1024 sc1
    buffer_load_dwordx4 v[40:43], v8, s[48:51], s68 offen offset:2048 sc1
    buffer_load_dwordx4 v[44:47], v8, s[48:51], s68 offen offset:3072 sc1
    s_add_u32 s96, s96, 1
    s_cmp_ge_u32 s96, 40000
    s_cbranch_scc1 L_done
    s_add_u32 s47, s47, 1
    s_cmp_eq_u32 s47, 24
    s_cbranch_scc1 L_qpg
L_qpb:
    s_waitcnt vmcnt(0)
    v_mfma_f32_16x16x32_bf16 v[48:51], v[32:35], a[64:67], 0
    v_xor_b32 v23, s40, v32
    v_bitop3_b32 v23, v33, s41, v23 bitop3:0xbe
    v_mfma_f32_16x16x32_bf16 v[48:51], v[36:39], a[68:71], v[48:51]
    v_bitop3_b32 v23, v34, s42, v23 bitop3:0xbe
    v_bitop3_b32 v23, v35, s43, v23 bitop3:0xbe
    v_mfma_f32_16x16x32_bf16 v[48:51], v[40:43], a[72:75], v[48:51]
    v_bitop3_b32 v23, v36, s40, v23 bitop3:0xbe
    v_bitop3_b32 v23, v37, s41, v23 bitop3:0xbe
    v_mfma_f32_16x16x32_bf16 v[48:51], v[44:47], a[76:79], v[48:51]
    v_bitop3_b32 v23, v38, s42, v23 bitop3:0xbe
    v_bitop3_b32 v23, v39, s43, v23 bitop3:0xbe
    v_mfma_f32_16x16x32_bf16 v[52:55], v[32:35], a[80:83], 0
    v_bitop3_b32 v23, v40, s40, v23 bitop3:0xbe
    v_bitop3_b32 v23, v41, s41, v23 bitop3:0xbe
    v_mfma_f32_16x16x32_bf16 v[52:55], v[36:39], a[84:87], v[52:55]
    v_bitop3_b32 v23, v42, s42, v23 bitop3:0xbe
    v_bitop3_b32 v23, v43, s43, v23 bitop3:0xbe
    v_mfma_f32_16x16x32_bf16 v[52:55], v[40:43], a[88:91], v[52:55]
    v_bitop3_b32 v23, v44, s40, v23 bitop3:0xbe
    v_bitop3_b32 v23, v45, s41, v23 bitop3:0xbe
    v_mfma_f32_16x16x32_bf16 v[52:55], v[44:47], a[92:95], v[52:55]
    v_bitop3_b32 v23, v46, s42, v23 bitop3:0xbe
    v_bitop3_b32 v23, v47, s43, v23 bitop3:0xbe
    v_and_b32 v23, 0x10001, v23
    v_cmp_ne_u32 vcc, 0, v23
    v_add_f32 v48, v48, v49
    v_add_f32 v50, v50, v51
    v_add_f32 v48, v48, v50
    s_cbranch_vccnz L_qp
    v_add_f32 v52, v52, v53
    v_add_f32 v54, v54, v55
    v_add_f32 v52, v52, v54
    v_cndmask_b32 v48, v48, v52, s[100:101]
    s_nop 1
    v_mov_b32_dpp v25, v48 quad_perm:[1,0,3,2] row_mask:0xf bank_mask:0xf
    v_cvt_pk_bf16_f32 v24, v48, v25
    v_and_or_b32 v24, v24, v5, v7
    s_nop 1
    v_mov_b32_dpp v25, v24 row_ror:14 row_mask:0xf bank_mask:0xf
    v_mov_b32_dpp v26, v24 row_ror:12 row_mask:0xf bank_mask:0xf
    v_mov_b32_dpp v27, v24 row_ror:10 row_mask:0xf bank_mask:0xf
    s_mov_b32 exec_lo, 0x1000001
    s_mov_b32 exec_hi, 0x1000001
    buffer_store_dwordx4 v[24:27], v11, s[48:51], s71 offen sc1
    s_mov_b32 exec_lo, 0x10001
    s_mov_b32 exec_hi, 0x10001
    buffer_store_dwordx4 v[12:15], v11, s[48:51], s70 offen sc1
    s_mov_b64 exec, -1
    s_lshr_b32 s69, s37, 1
    s_cmp_ge_u32 s69, 4
    s_addc_u32 s69, s69, 0
    s_sub_u32 s68, 3, s36
    s_and_b32 s68, s68, 7
    s_add_u32 s68, s68, s69
    s_sub_u32 s97, s68, 9
    s_cmp_ge_u32 s68, 9
    s_cselect_b32 s68, s97, s68
    s_mul_i32 s97, s36, 9
    s_add_u32 s97, s97, s68
    s_and_b32 s68, s37, 1
    s_lshl1_add_u32 s97, s97, s68
    s_barrier
    s_sub_u32 s46, s37, 2
    s_lshl3_add_u32 s46, s46, s36
    s_cmp_ge_u32 s46, 108
    s_cbranch_scc1 L_na2
    s_mul_i32 s45, s46, 1821
    s_lshr_b32 s45, s45, 16
    s_mul_i32 s44, s45, 36
    s_sub_u32 s44, s46, s44
    v_lshlrev_b32 v8, 2, v0
    s_mov_b64 s[64:65], s[26:27]
    s_mov_b32 s66, 3981312
    s_mov_b32 s67, 0x20000
    s_mov_b64 s[56:57], s[24:25]
    s_mov_b32 s58, 1152
    s_mov_b32 s59, 0x20000
    v_lshrrev_b32 v10, 3, v1
    v_and_b32 v9, 6, v10
    v_xor_b32 v9, v9, v1
    v_and_b32 v9, 7, v9
    v_lshlrev_b32 v9, 4, v9
    v_lshrrev_b32 v11, 2, v10
    v_and_b32 v10, 3, v10
    v_mov_b32 v12, 55296
    v_mad_u32_u24 v9, v11, v12, v9
    v_mov_b32 v12, 6912
    v_mad_u32_u24 v9, v10, v12, v9
    s_and_b32 s68, s35, 1
    s_lshl_b32 s68, s68, 4
    s_and_b32 s69, s35, 2
    s_lshl_b32 s69, s69, 1
    s_add_u32 s68, s68, s69
    s_mul_i32 s69, s45, 192
    s_add_u32 s68, s68, s69
    s_mul_i32 s68, s68, 6912
    s_lshl_b32 s70, s44, 7
    s_add_u32 s68, s68, s70
    s_add_u32 s68, s68, 2304
    s_lshl_b32 s69, s69, 1
    s_lshl_b32 m0, s35, 10
    s_add_u32 m0, m0, 73728
    buffer_load_dword v16, v8, s[56:59], s69 offen
    buffer_load_dwordx4 v9, s[64:67], s68 offen nt lds
    s_add_u32 s68, s68, 221184
    s_add_u32 m0, m0, 4096
    s_nop 0
    buffer_load_dwordx4 v9, s[64:67], s68 offen nt lds
    s_add_u32 s68, s68, 221184
    s_add_u32 m0, m0, 4096
    s_nop 0
    buffer_load_dwordx4 v9, s[64:67], s68 offen nt lds
    s_add_u32 s68, s68, 221184
    s_add_u32 m0, m0, 4096
    s_nop 0
    buffer_load_dwordx4 v9, s[64:67], s68 offen nt lds
    s_add_u32 s68, s68, 221184
    s_add_u32 m0, m0, 4096
    s_nop 0
    buffer_load_dwordx4 v9, s[64:67], s68 offen nt lds
    s_add_u32 s68, s68, 221184
    s_add_u32 m0, m0, 4096
    s_nop 0
    buffer_load_dwordx4 v9, s[64:67], s68 offen nt lds
L_na2:
    s_mov_b64 s[52:53], s[18:19]
    s_mov_b32 s54, 5308416
    s_mov_b32 s55, 0x20000
    s_mov_b64 s[56:57], s[20:21]
    s_mov_b32 s58, 5308416
    s_mov_b32 s59, 0x20000
    s_mov_b64 s[60:61], s[22:23]
    s_mov_b32 s62, 5308416
    s_mov_b32 s63, 0x20000
    v_lshrrev_b32 v12, 3, v1
    v_and_b32 v244, 6, v12
    v_xor_b32 v244, v244, v1
    v_and_b32 v244, 7, v244
    v_lshlrev_b32 v244, 4, v244
    v_lshrrev_b32 v13, 2, v12
    v_and_b32 v12, 3, v12
    v_mov_b32 v14, 73728
    v_mad_u32_u24 v244, v13, v14, v244
    v_mov_b32 v14, 9216
    v_mad_u32_u24 v244, v12, v14, v244
    v_lshrrev_b32 v12, 3, v1
    v_and_b32 v246, 6, v12
    v_xor_b32 v246, v246, v1
    v_and_b32 v246, 7, v246
    v_lshlrev_b32 v246, 4, v246
    v_lshrrev_b32 v13, 2, v12
    v_and_b32 v12, 3, v12
    v_mov_b32 v14, 9216
    v_mad_u32_u24 v246, v13, v14, v246
    v_mov_b32 v14, 1152
    v_mad_u32_u24 v246, v12, v14, v246
    s_and_b32 s99, s35, 1
    s_lshl_b32 s99, s99, 4
    s_and_b32 s68, s35, 2
    s_lshl_b32 s68, s68, 1
    s_add_u32 s99, s99, s68
    s_and_b32 s30, s97, 1
    s_mul_i32 s68, s30, 288
    s_add_u32 s99, s99, s68
    s_mul_i32 s99, s99, 9216
    s_lshr_b32 s68, s97, 1
    s_lshl_b32 s68, s68, 7
    s_add_u32 s99, s99, s68
    s_lshl_b32 s3, s35, 10
    s_and_b32 s68, s35, 1
    s_lshl_b32 s68, s68, 4
    s_and_b32 s69, s35, 2
    s_lshl_b32 s69, s69, 1
    s_add_u32 s68, s68, s69
    s_lshl_b32 s69, s97, 5
    s_add_u32 s68, s68, s69
    s_mul_i32 s68, s68, 1152
    s_add_u32 m0, s3, 110592
    s_nop 0
    buffer_load_dwordx4 v246, s[60:63], s68 offen nt lds
    s_add_u32 m0, s3, 114560
    s_nop 0
    buffer_load_dwordx4 v246, s[60:63], s68 offen offset:128 nt lds
    s_add_u32 m0, s3, 118528
    s_nop 0
    buffer_load_dwordx4 v246, s[60:63], s68 offen offset:256 nt lds
    s_add_u32 m0, s3, 122496
    s_nop 0
    buffer_load_dwordx4 v246, s[60:63], s68 offen offset:384 nt lds
    s_add_u32 m0, s3, 126464
    s_nop 0
    buffer_load_dwordx4 v246, s[60:63], s68 offen offset:512 nt lds
    s_add_u32 m0, s3, 130432
    s_nop 0
    buffer_load_dwordx4 v246, s[60:63], s68 offen offset:640 nt lds
    s_add_u32 m0, s3, 134400
    s_nop 0
    buffer_load_dwordx4 v246, s[60:63], s68 offen offset:768 nt lds
    s_add_u32 m0, s3, 138368
    s_nop 0
    buffer_load_dwordx4 v246, s[60:63], s68 offen offset:896 nt lds
    s_add_u32 m0, s3, 142336
    s_nop 0
    buffer_load_dwordx4 v246, s[60:63], s68 offen offset:1024 nt lds
    s_cmp_ge_u32 s46, 108
    s_cbranch_scc1 L_na3
    s_mul_i32 s68, s45, 9216
    s_lshl2_add_u32 s69, s44, s35
    s_lshl_b32 s69, s69, 6
    s_add_u32 s68, s68, s69
    s_add_u32 s68, s68, 229376
    v_lshrrev_b32 v22, 2, v1
    v_lshlrev_b32 v20, 7, v22
    v_lshrrev_b32 v22, 1, v22
    v_and_b32 v22, 3, v22
    v_xor_b32 v22, s35, v22
    v_lshl_add_u32 v20, v22, 5, v20
    v_and_b32 v22, 3, v1
    v_lshl_add_u32 v20, v22, 3, v20
    v_add_u32 v20, 73728, v20
    v_lshlrev_b32 v21, 4, v2
    v_add_u32 v22, 98304, v21
    v_add_u32 v8, 98304, v8
    s_waitcnt vmcnt(15)
    v_lshlrev_b32 v24, 16, v16
    v_and_b32 v25, 0xffff0000, v16
    v_mul_f32 v26, 0xbfb8aa3b, v24
    v_mul_f32 v27, 0xbfb8aa3b, v25
    v_exp_f32 v26, v26
    v_exp_f32 v27, v27
    v_add_f32 v26, 1.0, v26
    v_add_f32 v27, 1.0, v27
    v_rcp_f32 v26, v26
    v_rcp_f32 v27, v27
    v_mul_f32 v24, v24, v26
    v_mul_f32 v25, v25, v27
    v_cvt_pk_bf16_f32 v16, v24, v25
    ds_write_b32 v8, v16
    s_waitcnt vmcnt(9) lgkmcnt(0)
    s_barrier
    ds_read_b64_tr_b16 v[64:65], v20 offset:0
    ds_read_b64_tr_b16 v[66:67], v20 offset:2048
    ds_read_b128 v[88:91], v22 offset:0
    ds_read_b64_tr_b16 v[68:69], v20 offset:4096
    ds_read_b64_tr_b16 v[70:71], v20 offset:6144
    ds_read_b128 v[92:95], v22 offset:64
    ds_read_b64_tr_b16 v[72:73], v20 offset:8192
    ds_read_b64_tr_b16 v[74:75], v20 offset:10240
    ds_read_b128 v[96:99], v22 offset:128
    ds_read_b64_tr_b16 v[76:77], v20 offset:12288
    ds_read_b64_tr_b16 v[78:79], v20 offset:14336
    ds_read_b128 v[100:103], v22 offset:192
    ds_read_b64_tr_b16 v[80:81], v20 offset:16384
    ds_read_b64_tr_b16 v[82:83], v20 offset:18432
    ds_read_b128 v[104:107], v22 offset:256
    ds_read_b64_tr_b16 v[84:85], v20 offset:20480
    ds_read_b64_tr_b16 v[86:87], v20 offset:22528
    ds_read_b128 v[108:111], v22 offset:320
    s_waitcnt lgkmcnt(15)
    v_mfma_f32_16x16x32_bf16 v[24:27], v[64:67], v[88:91], 0
    s_waitcnt lgkmcnt(12)
    v_mfma_f32_16x16x32_bf16 v[24:27], v[68:71], v[92:95], v[24:27]
    s_waitcnt lgkmcnt(9)
    v_mfma_f32_16x16x32_bf16 v[24:27], v[72:75], v[96:99], v[24:27]
    s_waitcnt lgkmcnt(6)
    v_mfma_f32_16x16x32_bf16 v[24:27], v[76:79], v[100:103], v[24:27]
    s_waitcnt lgkmcnt(3)
    v_mfma_f32_16x16x32_bf16 v[24:27], v[80:83], v[104:107], v[24:27]
    s_waitcnt lgkmcnt(0)
    v_mfma_f32_16x16x32_bf16 v[24:27], v[84:87], v[108:111], v[24:27]
    s_nop 7
    v_and_or_b32 v24, v24, v6, s39
    v_and_or_b32 v25, v25, v6, s39
    v_and_or_b32 v26, v26, v6, s39
    v_and_or_b32 v27, v27, v6, s39
    s_mov_b32 exec_lo, 0x10001
    s_mov_b32 exec_hi, 0x10001
    buffer_store_dwordx4 v[24:27], v21, s[48:51], s68 offen sc1
    s_mov_b64 exec, -1
L_na3:
    s_cmp_lt_u32 s37, 7
    s_cbranch_scc1 L_ft0
    s_branch L_pf
L_qpg:
    s_mov_b32 exec_lo, 0x10001
    s_mov_b32 exec_hi, 0x10001
    buffer_store_dwordx4 v[12:15], v11, s[48:51], s70 offen sc1
    s_mov_b64 exec, -1
    s_add_u32 s68, s68, 131072
    s_branch L_qpb
L_pf:
    s_sub_u32 s46, s37, 7
    s_sub_u32 s68, 3, s36
    s_and_b32 s68, s68, 7
    s_add_u32 s68, s68, 4
    s_sub_u32 s69, s68, 9
    s_cmp_ge_u32 s68, 9
    s_cselect_b32 s68, s69, s68
    s_mul_i32 s69, s36, 9
    s_add_u32 s69, s69, s68
    s_lshl2_add_u32 s46, s46, s35
    s_mul_i32 s70, s46, 147456
    s_lshl_b32 s68, s69, 7
    s_add_u32 s70, s70, s68
    s_mul_i32 s71, s69, 73728
    s_lshl_b32 s68, s46, 11
    s_add_u32 s71, s71, s68
    v_mul_u32_u24 v12, 9216, v1
    v_lshlrev_b32 v13, 7, v1
    s_mov_b64 exec, 0xffff
    buffer_load_dword v242, v12, s[52:55], s70 offen
    buffer_load_dword v243, v12, s[56:59], s70 offen
    buffer_load_dword v240, v13, s[60:63], s71 offen
    s_mov_b64 exec, -1
    s_branch L_ft0
L_ft0:
    s_add_u32 m0, s3, 0
    s_add_u32 s68, s99, 0
    buffer_load_dwordx4 v244, s[52:55], s68 offen nt lds
    s_add_u32 m0, s3, 36864
    s_add_u32 s68, s99, 0
    buffer_load_dwordx4 v244, s[56:59], s68 offen nt lds
    s_add_u32 m0, s3, 4096
    s_add_u32 s68, s99, 294912
    buffer_load_dwordx4 v244, s[52:55], s68 offen nt lds
L_ft1:
    s_add_u32 m0, s3, 40960
    s_add_u32 s68, s99, 294912
    buffer_load_dwordx4 v244, s[56:59], s68 offen nt lds
    s_add_u32 m0, s3, 8192
    s_add_u32 s68, s99, 589824
    buffer_load_dwordx4 v244, s[52:55], s68 offen nt lds
    s_add_u32 m0, s3, 45056
    s_add_u32 s68, s99, 589824
    buffer_load_dwordx4 v244, s[56:59], s68 offen nt lds
L_ft2:
    s_add_u32 m0, s3, 12288
    s_add_u32 s68, s99, 884736
    buffer_load_dwordx4 v244, s[52:55], s68 offen nt lds
    s_add_u32 m0, s3, 49152
    s_add_u32 s68, s99, 884736
    buffer_load_dwordx4 v244, s[56:59], s68 offen nt lds
    s_add_u32 m0, s3, 16384
    s_add_u32 s68, s99, 1179648
    buffer_load_dwordx4 v244, s[52:55], s68 offen nt lds
L_ft3:
    s_add_u32 m0, s3, 53248
    s_add_u32 s68, s99, 1179648
    buffer_load_dwordx4 v244, s[56:59], s68 offen nt lds
    s_add_u32 m0, s3, 20480
    s_add_u32 s68, s99, 1474560
    buffer_load_dwordx4 v244, s[52:55], s68 offen nt lds
    s_add_u32 m0, s3, 57344
    s_add_u32 s68, s99, 1474560
    buffer_load_dwordx4 v244, s[56:59], s68 offen nt lds
L_ft4:
    v_min_u32 v9, 35, v1
    v_lshlrev_b32 v8, 4, v9
    s_and_b32 s7, s35, 1
    s_lshl1_add_u32 s4, s30, s7
    s_mul_i32 s4, s4, 576
    s_cmp_ge_u32 s35, 2
    s_cselect_b32 s5, 0, 2304
    s_cselect_b32 s8, 0, 1.0
    s_cselect_b32 s9, 592, 0
    s_add_u32 s9, s9, 147456
    s_add_u32 s4, s4, s5
    s_add_u32 s4, s4, 231680
    s_add_u32 s5, s4, 9216
    s_add_u32 s6, s4, 18432
    buffer_load_dwordx4 v[64:67], v8, s[48:51], s4 offen sc1
    buffer_load_dwordx4 v[68:71], v8, s[48:51], s5 offen sc1
    buffer_load_dwordx4 v[72:75], v8, s[48:51], s6 offen sc1
    s_add_u32 m0, s3, 24576
    s_add_u32 s68, s99, 1769472
    buffer_load_dwordx4 v244, s[52:55], s68 offen nt lds
    s_add_u32 m0, s3, 61440
    s_add_u32 s68, s99, 1769472
    buffer_load_dwordx4 v244, s[56:59], s68 offen nt lds
    s_add_u32 m0, s3, 28672
    s_add_u32 s68, s99, 2064384
    buffer_load_dwordx4 v244, s[52:55], s68 offen nt lds
L_ft5:
    s_add_u32 m0, s3, 65536
    s_add_u32 s68, s99, 2064384
    buffer_load_dwordx4 v244, s[56:59], s68 offen nt lds
    s_add_u32 m0, s3, 32768
    s_add_u32 s68, s99, 2359296
    buffer_load_dwordx4 v244, s[52:55], s68 offen nt lds
    s_add_u32 m0, s3, 69632
    s_add_u32 s68, s99, 2359296
    buffer_load_dwordx4 v244, s[56:59], s68 offen nt lds
L_ft6:
    s_mul_i32 s68, s7, 288
    s_add_u32 s9, s9, s68
    v_lshl_add_u32 v9, v9, 3, s9
    s_lshr_b32 s68, s35, 1
    s_lshl_b32 s10, s68, 2
    s_xor_b32 s11, s7, s30
    s_lshl1_add_u32 s11, s11, s68
    s_lshl_b32 s12, s97, 11
    s_xor_b32 s13, s12, 2048
    s_lshl_b32 s68, s68, 10
    s_add_u32 s13, s13, s68
    s_lshl_b32 s68, s7, 1
    v_lshrrev_b32 v11, 2, v1
    v_lshlrev_b32 v10, 7, v11
    v_lshrrev_b32 v11, 1, v11
    v_and_b32 v11, 3, v11
    v_xor_b32 v11, s68, v11
    v_lshl_add_u32 v10, v11, 5, v10
    v_and_b32 v11, 3, v1
    v_lshl_add_u32 v10, v11, 3, v10
    s_lshl_b32 s68, s10, 12
    v_add_u32 v10, s68, v10
    v_xor_b32 v11, 32, v10
    v_and_b32 v13, 1, v3
    v_mul_u32_u24 v13, 592, v13
    v_lshl_add_u32 v13, v2, 4, v13
    s_lshl_b32 s68, s10, 6
    s_add_u32 s68, s68, 147456
    v_add_u32 v13, s68, v13
    s_waitcnt vmcnt(6)
L_csb:
    v_xor_b32 v12, s39, v64
    v_bitop3_b32 v12, v65, s39, v12 bitop3:0xbe
    v_bitop3_b32 v12, v66, s39, v12 bitop3:0xbe
    v_bitop3_b32 v12, v67, s39, v12 bitop3:0xbe
    v_bitop3_b32 v12, v68, s39, v12 bitop3:0xbe
    v_bitop3_b32 v12, v69, s39, v12 bitop3:0xbe
    v_bitop3_b32 v12, v70, s39, v12 bitop3:0xbe
    v_bitop3_b32 v12, v71, s39, v12 bitop3:0xbe
    v_bitop3_b32 v12, v72, s39, v12 bitop3:0xbe
    v_bitop3_b32 v12, v73, s39, v12 bitop3:0xbe
    v_bitop3_b32 v12, v74, s39, v12 bitop3:0xbe
    v_bitop3_b32 v12, v75, s39, v12 bitop3:0xbe
    v_and_b32 v12, 0xff, v12
    v_cmp_ne_u32 vcc, 0, v12
    s_cbranch_vccnz L_cs
    v_add_f32 v64, v64, v68
    v_add_f32 v65, v65, v69
    v_add_f32 v66, v66, v70
    v_add_f32 v67, v67, v71
    v_add_f32 v64, v64, v72
    v_add_f32 v65, v65, v73
    v_add_f32 v66, v66, v74
    v_add_f32 v67, v67, v75
    v_cvt_pk_bf16_f32 v64, v64, v64
    v_and_b32 v64, 0xffff0000, v64
    v_add_f32 v64, s8, v64
    v_cvt_pk_bf16_f32 v65, v65, v65
    v_and_b32 v65, 0xffff0000, v65
    v_add_f32 v65, s8, v65
    v_cvt_pk_bf16_f32 v66, v66, v66
    v_and_b32 v66, 0xffff0000, v66
    v_add_f32 v66, s8, v66
    v_cvt_pk_bf16_f32 v67, v67, v67
    v_and_b32 v67, 0xffff0000, v67
    v_add_f32 v67, s8, v67
    v_cvt_pk_bf16_f32 v64, v64, v65
    v_cvt_pk_bf16_f32 v65, v66, v67
    ds_write_b64 v9, v[64:65]
    v_lshrrev_b32 v14, 2, v3
    v_lshlrev_b32 v14, 7, v14
    v_and_b32 v15, 1, v3
    v_lshl_add_u32 v14, v15, 6, v14
    v_and_b32 v15, 2, v3
    v_xor_b32 v15, 2, v15
    v_lshl_add_u32 v14, v15, 4, v14
    v_and_b32 v16, 1, v2
    v_lshl_add_u32 v14, v16, 4, v14
    v_lshrrev_b32 v19, 1, v2
    v_lshl_add_u32 v14, v19, 9, v14
    s_mul_i32 s70, s30, 9216
    s_add_u32 s70, s70, 278528
    s_lshl_b32 s69, s10, 10
    s_add_u32 s69, s69, s70
    s_add_u32 s70, s69, 4096
    v_lshl_add_u32 v19, v19, 4, v3
    v_lshlrev_b32 v21, 3, v19
    v_lshl_add_u32 v21, v16, 2, v21
    v_lshlrev_b32 v19, 5, v19
    v_lshl_add_u32 v19, v16, 4, v19
    s_lshl2_add_u32 s73, s11, 151552
    v_add_u32 v19, s73, v19
    v_and_b32 v12, 7, v3
    v_lshl_add_u32 v12, v2, 3, v12
    v_lshlrev_b32 v17, 5, v12
    v_add_u32 v17, 151552, v17
    v_lshlrev_b32 v28, 3, v12
    v_lshlrev_b32 v29, 4, v12
    v_lshlrev_b32 v30, 6, v12
    v_add_u32 v30, 149504, v30
    v_and_b32 v31, 31, v1
    v_lshlrev_b32 v31, 6, v31
    s_lshl4_add_u32 s73, s11, 149504
    v_add_u32 v31, s73, v31
    v_and_b32 v20, 2, v3
    v_lshlrev_b32 v20, 3, v20
    s_lshl2_add_u32 s73, s11, 152576
    v_add_u32 v20, s73, v20
    v_mov_b32 v18, 152576
    v_lshlrev_b32 v15, 2, v3
    v_mov_b32 v8, 0
    v_lshrrev_b32 v22, 5, v1
    v_lshrrev_b32 v16, 2, v3
    v_lshl_add_u32 v22, v22, 2, v16
    v_mul_u32_u24 v22, 9216, v22
    v_and_b32 v16, 3, v3
    v_lshl_add_u32 v22, v16, 4, v22
    v_lshlrev_b32 v23, 4, v2
    v_add_u32 v23, 73728, v23
    s_lshl_b32 s72, s97, 6
    s_mul_i32 s73, s35, 82944
    s_add_u32 s72, s72, s73
    s_add_u32 s72, s72, 327680
    s_mov_b32 s74, 0
    s_mov_b32 s75, -1
    s_mov_b32 s100, 0x33333333
    s_mov_b32 s101, 0x33333333
    s_mov_b32 s14, 0xffff0000
    s_mov_b32 s15, 0xffff0000
    s_cmp_ge_u32 s35, 2
    s_cselect_b64 s[16:17], -1, s[100:101]
    s_cselect_b32 s68, 0, 0x3f803f80
    v_mov_b32 v16, 0x3f803f80
    v_mov_b32 v9, s68
    s_add_u32 s4, s12, 6291456
    s_add_u32 s5, s13, 6291456
    s_add_u32 s12, s12, 688128
    s_add_u32 s13, s13, 688128
    s_mov_b32 s47, 0
    s_waitcnt vmcnt(0) lgkmcnt(0)
    s_barrier
    ds_read_b128 v[112:115], v13 offset:0
    ds_read_b128 v[116:119], v13 offset:64
    ds_read_b128 v[120:123], v13 offset:128
    ds_read_b128 v[124:127], v13 offset:192
    ds_read_b128 v[128:131], v13 offset:256
    ds_read_b64_tr_b16 a[16:17], v10 offset:4096
    ds_read_b64_tr_b16 a[18:19], v10 offset:6144
    ds_read_b64_tr_b16 a[20:21], v10 offset:40960
    ds_read_b64_tr_b16 a[22:23], v10 offset:43008
    ds_read_b64_tr_b16 a[24:25], v11 offset:4096
    ds_read_b64_tr_b16 a[26:27], v11 offset:6144
    ds_read_b64_tr_b16 a[28:29], v11 offset:40960
    ds_read_b64_tr_b16 a[30:31], v11 offset:43008
    ds_read_b64_tr_b16 a[32:33], v10 offset:8192
    ds_read_b64_tr_b16 a[34:35], v10 offset:10240
    ds_read_b64_tr_b16 a[36:37], v10 offset:45056
    ds_read_b64_tr_b16 a[38:39], v10 offset:47104
    ds_read_b64_tr_b16 a[40:41], v11 offset:8192
    ds_read_b64_tr_b16 a[42:43], v11 offset:10240
    ds_read_b64_tr_b16 a[44:45], v11 offset:45056
    ds_read_b64_tr_b16 a[46:47], v11 offset:47104
    ds_read_b64_tr_b16 a[48:49], v10 offset:12288
    ds_read_b64_tr_b16 a[50:51], v10 offset:14336
    ds_read_b64_tr_b16 a[52:53], v10 offset:49152
    ds_read_b64_tr_b16 a[54:55], v10 offset:51200
    ds_read_b64_tr_b16 a[56:57], v11 offset:12288
    ds_read_b64_tr_b16 a[58:59], v11 offset:14336
    ds_read_b64_tr_b16 a[60:61], v11 offset:49152
    ds_read_b64_tr_b16 a[62:63], v11 offset:51200
    ds_read_b64_tr_b16 a[64:65], v10 offset:16384
    ds_read_b64_tr_b16 a[66:67], v10 offset:18432
    ds_read_b64_tr_b16 a[68:69], v10 offset:53248
    ds_read_b64_tr_b16 a[70:71], v10 offset:55296
    ds_read_b64_tr_b16 a[72:73], v11 offset:16384
    ds_read_b64_tr_b16 a[74:75], v11 offset:18432
    ds_read_b64_tr_b16 a[76:77], v11 offset:53248
    ds_read_b64_tr_b16 a[78:79], v11 offset:55296
    s_cmp_ge_u32 s35, 2
    s_cbranch_scc1 L_fz
    ds_read_b64_tr_b16 a[0:1], v10 offset:0
    ds_read_b64_tr_b16 a[2:3], v10 offset:2048
    ds_read_b64_tr_b16 a[4:5], v10 offset:36864
    ds_read_b64_tr_b16 a[6:7], v10 offset:38912
    ds_read_b64_tr_b16 a[8:9], v11 offset:0
    ds_read_b64_tr_b16 a[10:11], v11 offset:2048
    ds_read_b64_tr_b16 a[12:13], v11 offset:36864
    ds_read_b64_tr_b16 a[14:15], v11 offset:38912
L_fzb:
    v_lshrrev_b32 v11, 2, v1
    v_lshlrev_b32 v10, 7, v11
    v_lshrrev_b32 v11, 1, v11
    v_and_b32 v11, 3, v11
    v_xor_b32 v11, 0, v11
    v_lshl_add_u32 v10, v11, 5, v10
    v_and_b32 v11, 3, v1
    v_lshl_add_u32 v10, v11, 3, v10
    v_add_u32 v10, 110592, v10
    s_waitcnt lgkmcnt(0)
    v_mfma_f32_16x16x32_bf16 v[32:35], v[112:115], a[0:3], 0
    v_mfma_f32_16x16x32_bf16 v[36:39], v[112:115], a[4:7], 0
    v_mfma_f32_16x16x32_bf16 v[40:43], v[112:115], a[8:11], 0
    v_mfma_f32_16x16x32_bf16 v[44:47], v[112:115], a[12:15], 0
    v_mfma_f32_16x16x32_bf16 v[32:35], v[116:119], a[16:19], v[32:35]
    v_mfma_f32_16x16x32_bf16 v[36:39], v[116:119], a[20:23], v[36:39]
    v_mfma_f32_16x16x32_bf16 v[40:43], v[116:119], a[24:27], v[40:43]
    v_mfma_f32_16x16x32_bf16 v[44:47], v[116:119], a[28:31], v[44:47]
    v_mfma_f32_16x16x32_bf16 v[32:35], v[120:123], a[32:35], v[32:35]
    v_mfma_f32_16x16x32_bf16 v[36:39], v[120:123], a[36:39], v[36:39]
    v_mfma_f32_16x16x32_bf16 v[40:43], v[120:123], a[40:43], v[40:43]
    v_mfma_f32_16x16x32_bf16 v[44:47], v[120:123], a[44:47], v[44:47]
    v_mfma_f32_16x16x32_bf16 v[32:35], v[124:127], a[48:51], v[32:35]
    v_mfma_f32_16x16x32_bf16 v[36:39], v[124:127], a[52:55], v[36:39]
    v_mfma_f32_16x16x32_bf16 v[40:43], v[124:127], a[56:59], v[40:43]
    v_mfma_f32_16x16x32_bf16 v[44:47], v[124:127], a[60:63], v[44:47]
    v_mfma_f32_16x16x32_bf16 v[32:35], v[128:131], a[64:67], v[32:35]
    v_mfma_f32_16x16x32_bf16 v[36:39], v[128:131], a[68:71], v[36:39]
    v_mfma_f32_16x16x32_bf16 v[40:43], v[128:131], a[72:75], v[40:43]
    v_mfma_f32_16x16x32_bf16 v[44:47], v[128:131], a[76:79], v[44:47]
    s_mul_i32 s68, s35, 9
    s_add_u32 s73, s68, 0
    s_and_b32 s71, s73, 3
    s_lshl_b32 s71, s71, 5
    s_lshr_b32 s73, s73, 2
    s_lshl_b32 s73, s73, 12
    v_xor_b32 v11, s71, v10
    v_add_u32 v11, s73, v11
    ds_read_b64_tr_b16 a[80:81], v11
    ds_read_b64_tr_b16 a[82:83], v11 offset:2048
    s_add_u32 s73, s68, 1
    s_and_b32 s71, s73, 3
    s_lshl_b32 s71, s71, 5
    s_lshr_b32 s73, s73, 2
    s_lshl_b32 s73, s73, 12
    v_xor_b32 v11, s71, v10
    v_add_u32 v11, s73, v11
    ds_read_b64_tr_b16 a[84:85], v11
    ds_read_b64_tr_b16 a[86:87], v11 offset:2048
    s_add_u32 s73, s68, 2
    s_and_b32 s71, s73, 3
    s_lshl_b32 s71, s71, 5
    s_lshr_b32 s73, s73, 2
    s_lshl_b32 s73, s73, 12
    v_xor_b32 v11, s71, v10
    v_add_u32 v11, s73, v11
    ds_read_b64_tr_b16 a[88:89], v11
    ds_read_b64_tr_b16 a[90:91], v11 offset:2048
    s_add_u32 s73, s68, 3
    s_and_b32 s71, s73, 3
    s_lshl_b32 s71, s71, 5
    s_lshr_b32 s73, s73, 2
    s_lshl_b32 s73, s73, 12
    v_xor_b32 v11, s71, v10
    v_add_u32 v11, s73, v11
    ds_read_b64_tr_b16 a[92:93], v11
    ds_read_b64_tr_b16 a[94:95], v11 offset:2048
    s_add_u32 s73, s68, 4
    s_and_b32 s71, s73, 3
    s_lshl_b32 s71, s71, 5
    s_lshr_b32 s73, s73, 2
    s_lshl_b32 s73, s73, 12
    v_xor_b32 v11, s71, v10
    v_add_u32 v11, s73, v11
    ds_read_b64_tr_b16 a[96:97], v11
    ds_read_b64_tr_b16 a[98:99], v11 offset:2048
    s_add_u32 s73, s68, 5
    s_and_b32 s71, s73, 3
    s_lshl_b32 s71, s71, 5
    s_lshr_b32 s73, s73, 2
    s_lshl_b32 s73, s73, 12
    v_xor_b32 v11, s71, v10
    v_add_u32 v11, s73, v11
    ds_read_b64_tr_b16 a[100:101], v11
    ds_read_b64_tr_b16 a[102:103], v11 offset:2048
    s_add_u32 s73, s68, 6
    s_and_b32 s71, s73, 3
    s_lshl_b32 s71, s71, 5
    s_lshr_b32 s73, s73, 2
    s_lshl_b32 s73, s73, 12
    v_xor_b32 v11, s71, v10
    v_add_u32 v11, s73, v11
    ds_read_b64_tr_b16 a[104:105], v11
    ds_read_b64_tr_b16 a[106:107], v11 offset:2048
    s_add_u32 s73, s68, 7
    s_and_b32 s71, s73, 3
    s_lshl_b32 s71, s71, 5
    s_lshr_b32 s73, s73, 2
    s_lshl_b32 s73, s73, 12
    v_xor_b32 v11, s71, v10
    v_add_u32 v11, s73, v11
    ds_read_b64_tr_b16 a[108:109], v11
    ds_read_b64_tr_b16 a[110:111], v11 offset:2048
    s_add_u32 s73, s68, 8
    s_and_b32 s71, s73, 3
    s_lshl_b32 s71, s71, 5
    s_lshr_b32 s73, s73, 2
    s_lshl_b32 s73, s73, 12
    v_xor_b32 v11, s71, v10
    v_add_u32 v11, s73, v11
    ds_read_b64_tr_b16 a[112:113], v11
    ds_read_b64_tr_b16 a[114:115], v11 offset:2048
    v_cndmask_b32 v152, v32, v40, s[14:15]
    v_and_or_b32 v152, v152, v6, s39
    v_cndmask_b32 v153, v33, v41, s[14:15]
    v_and_or_b32 v153, v153, v6, s39
    v_cndmask_b32 v154, v36, v44, s[14:15]
    v_and_or_b32 v154, v154, v6, s39
    v_cndmask_b32 v155, v37, v45, s[14:15]
    v_and_or_b32 v155, v155, v6, s39
    ds_write_b128 v31, v[152:155]
    v_and_b32 v31, 0x1f0, v4
    s_cmp_lt_u32 s11, 2
    s_cbranch_scc1 L_nuv
    buffer_store_dwordx4 v[152:155], v31, s[48:51], s13 offen
L_nuv:
    s_waitcnt lgkmcnt(0)
    s_barrier
    buffer_load_dwordx2 v[80:81], v28, s[48:51], s12 offen offset:512 sc1
    buffer_load_dwordx4 v[84:87], v8, s[48:51], s12 offen offset:768 sc1
    buffer_load_dwordx2 v[88:89], v28, s[48:51], s12 offen offset:1536 sc1
    buffer_load_dwordx4 v[92:95], v8, s[48:51], s12 offen offset:1792 sc1
    buffer_load_dwordx4 v[96:99], v29, s[48:51], s12 offen sc1
    buffer_load_dwordx4 v[100:103], v29, s[48:51], s12 offen offset:1024 sc1
    ds_read_b128 v[32:35], v30 offset:0
    ds_read_b128 v[36:39], v30 offset:16
    s_waitcnt lgkmcnt(0)
    v_add_f32 v24, v32, v36
    v_add_f32 v25, v33, v37
    v_add_f32 v26, v34, v38
    v_add_f32 v27, v35, v39
    s_lshl2_add_u32 s71, s36, s35
    s_lshl_b32 s71, s71, 10
    s_add_u32 s71, s71, 196864
    s_mov_b64 exec, 15
L_tg2:
    buffer_load_dwordx4 v[112:115], v4, s[48:51], s71 offen sc1
    s_add_u32 s96, s96, 1
    s_cmp_ge_u32 s96, 40000
    s_cbranch_scc1 L_done
    s_waitcnt vmcnt(0)
    v_xor_b32 v12, s40, v112
    v_bitop3_b32 v12, v113, s41, v12 bitop3:0xbe
    v_bitop3_b32 v12, v114, s42, v12 bitop3:0xbe
    v_bitop3_b32 v12, v115, s43, v12 bitop3:0xbe
    v_and_b32 v12, 0x10001, v12
    v_cmp_ne_u32 vcc, 0, v12
    s_cbranch_vccnz L_tg2
    s_mov_b64 exec, -1
L_tr:
    buffer_load_dwordx4 v[112:115], v14, s[48:51], s69 offen sc1
    buffer_load_dwordx4 v[116:119], v14, s[48:51], s69 offen offset:1024 sc1
    buffer_load_dwordx4 v[120:123], v14, s[48:51], s69 offen offset:2048 sc1
    buffer_load_dwordx4 v[124:127], v14, s[48:51], s69 offen offset:3072 sc1
    buffer_load_dwordx4 v[128:131], v14, s[48:51], s70 offen sc1
    s_add_u32 s96, s96, 1
    s_cmp_ge_u32 s96, 40000
    s_cbranch_scc1 L_done
    s_waitcnt vmcnt(0)
    v_mfma_f32_16x16x32_bf16 v[32:35], v[112:115], a[0:3], 0
    v_xor_b32 v12, s40, v112
    v_bitop3_b32 v12, v113, s41, v12 bitop3:0xbe
    v_bitop3_b32 v12, v114, s42, v12 bitop3:0xbe
    v_mfma_f32_16x16x32_bf16 v[36:39], v[112:115], a[4:7], 0
    v_bitop3_b32 v12, v115, s43, v12 bitop3:0xbe
    v_bitop3_b32 v12, v116, s40, v12 bitop3:0xbe
    v_bitop3_b32 v12, v117, s41, v12 bitop3:0xbe
    v_mfma_f32_16x16x32_bf16 v[40:43], v[112:115], a[8:11], 0
    v_bitop3_b32 v12, v118, s42, v12 bitop3:0xbe
    v_bitop3_b32 v12, v119, s43, v12 bitop3:0xbe
    v_bitop3_b32 v12, v120, s40, v12 bitop3:0xbe
    v_mfma_f32_16x16x32_bf16 v[44:47], v[112:115], a[12:15], 0
    v_bitop3_b32 v12, v121, s41, v12 bitop3:0xbe
    v_bitop3_b32 v12, v122, s42, v12 bitop3:0xbe
    v_bitop3_b32 v12, v123, s43, v12 bitop3:0xbe
    v_mfma_f32_16x16x32_bf16 v[32:35], v[116:119], a[16:19], v[32:35]
    v_bitop3_b32 v12, v124, s40, v12 bitop3:0xbe
    v_bitop3_b32 v12, v125, s41, v12 bitop3:0xbe
    v_bitop3_b32 v12, v126, s42, v12 bitop3:0xbe
    v_mfma_f32_16x16x32_bf16 v[36:39], v[116:119], a[20:23], v[36:39]
    v_bitop3_b32 v12, v127, s43, v12 bitop3:0xbe
    v_bitop3_b32 v12, v128, s40, v12 bitop3:0xbe
    v_bitop3_b32 v12, v129, s41, v12 bitop3:0xbe
    v_mfma_f32_16x16x32_bf16 v[40:43], v[116:119], a[24:27], v[40:43]
    v_bitop3_b32 v12, v130, s42, v12 bitop3:0xbe
    v_bitop3_b32 v12, v131, s43, v12 bitop3:0xbe
    v_and_b32 v12, 0x10001, v12
    v_cmp_ne_u32 vcc, 0, v12
    s_cbranch_vccnz L_tr
    v_cndmask_b32 v132, v112, v9, s[16:17]
    v_cndmask_b32 v133, v113, v9, s[16:17]
    v_mfma_f32_16x16x32_bf16 v[44:47], v[116:119], a[28:31], v[44:47]
    v_cndmask_b32 v134, v114, v9, s[16:17]
    v_cndmask_b32 v135, v115, v9, s[16:17]
    s_nop 1
    v_mfma_f32_16x16x32_bf16 v[48:51], v[112:115], v[132:135], 0
    v_cndmask_b32 v136, v116, v16, s[100:101]
    v_cndmask_b32 v137, v117, v16, s[100:101]
    v_mfma_f32_16x16x32_bf16 v[32:35], v[120:123], a[32:35], v[32:35]
    v_cndmask_b32 v138, v118, v16, s[100:101]
    v_cndmask_b32 v139, v119, v16, s[100:101]
    s_nop 1
    v_mfma_f32_16x16x32_bf16 v[48:51], v[116:119], v[136:139], v[48:51]
    v_cndmask_b32 v140, v120, v16, s[100:101]
    v_cndmask_b32 v141, v121, v16, s[100:101]
    v_mfma_f32_16x16x32_bf16 v[36:39], v[120:123], a[36:39], v[36:39]
    v_cndmask_b32 v142, v122, v16, s[100:101]
    v_cndmask_b32 v143, v123, v16, s[100:101]
    s_nop 1
    v_mfma_f32_16x16x32_bf16 v[48:51], v[120:123], v[140:143], v[48:51]
    v_cndmask_b32 v144, v124, v16, s[100:101]
    v_cndmask_b32 v145, v125, v16, s[100:101]
    v_mfma_f32_16x16x32_bf16 v[40:43], v[120:123], a[40:43], v[40:43]
    v_cndmask_b32 v146, v126, v16, s[100:101]
    v_cndmask_b32 v147, v127, v16, s[100:101]
    s_nop 1
    v_mfma_f32_16x16x32_bf16 v[48:51], v[124:127], v[144:147], v[48:51]
    v_cndmask_b32 v148, v128, v16, s[100:101]
    v_cndmask_b32 v149, v129, v16, s[100:101]
    v_mfma_f32_16x16x32_bf16 v[44:47], v[120:123], a[44:47], v[44:47]
    v_cndmask_b32 v150, v130, v16, s[100:101]
    v_cndmask_b32 v151, v131, v16, s[100:101]
    s_nop 1
    v_mfma_f32_16x16x32_bf16 v[48:51], v[128:131], v[148:151], v[48:51]
    v_mfma_f32_16x16x32_bf16 v[32:35], v[124:127], a[48:51], v[32:35]
    v_mfma_f32_16x16x32_bf16 v[36:39], v[124:127], a[52:55], v[36:39]
    v_add_f32 v48, v50, v51
    v_mfma_f32_16x16x32_bf16 v[40:43], v[124:127], a[56:59], v[40:43]
    s_nop 0
    v_add_f32_dpp v48, v48, v48 quad_perm:[1,0,3,2] row_mask:0xf bank_mask:0xf
    v_mfma_f32_16x16x32_bf16 v[44:47], v[124:127], a[60:63], v[44:47]
    s_nop 0
    v_add_f32_dpp v48, v48, v48 row_ror:4 row_mask:0xf bank_mask:0xf
    v_mfma_f32_16x16x32_bf16 v[32:35], v[128:131], a[64:67], v[32:35]
    s_nop 0
    v_add_f32_dpp v48, v48, v48 row_ror:8 row_mask:0xf bank_mask:0xf
    v_mov_b32 v49, v48
    v_mfma_f32_16x16x32_bf16 v[36:39], v[128:131], a[68:71], v[36:39]
    s_nop 0
    v_permlane16_swap_b32 v48, v49
    v_add_f32 v48, v48, v49
    v_mfma_f32_16x16x32_bf16 v[40:43], v[128:131], a[72:75], v[40:43]
    v_mov_b32 v49, v48
    v_mfma_f32_16x16x32_bf16 v[44:47], v[128:131], a[76:79], v[44:47]
    s_nop 0
    v_permlane32_swap_b32 v48, v49
    v_add_f32 v48, v48, v49
    ds_write_b32 v20, v48
    v_and_or_b32 v133, v48, v6, s39
    v_add_f32 v32, v32, v33
    v_add_f32 v36, v36, v37
    v_add_f32 v40, v40, v41
    v_add_f32 v44, v44, v45
    s_nop 0
    v_permlane32_swap_b32 v32, v40
    v_permlane32_swap_b32 v36, v44
    v_add_f32 v32, v32, v40
    v_add_f32 v36, v36, v44
    s_nop 1
    v_permlane16_swap_b32 v32, v36
    s_cmp_lt_u32 s11, 2
    v_add_f32 v32, v32, v36
    s_cbranch_scc1 L_nz
    v_and_or_b32 v132, v32, v6, s39
    buffer_store_dword v132, v21, s[48:51], s13 offen offset:512
    buffer_store_dword v133, v15, s[48:51], s13 offen offset:768
L_nz:
    ds_write_b32 v19, v32
    v_mov_b32 v49, 0x3727c5ac
    buffer_load_dwordx2 v[80:81], v28, s[48:51], s12 offen offset:512 sc1
    buffer_load_dwordx4 v[84:87], v8, s[48:51], s12 offen offset:768 sc1
    buffer_load_dwordx2 v[88:89], v28, s[48:51], s12 offen offset:1536 sc1
    buffer_load_dwordx4 v[92:95], v8, s[48:51], s12 offen offset:1792 sc1
    buffer_load_dwordx4 v[96:99], v29, s[48:51], s12 offen sc1
    buffer_load_dwordx4 v[100:103], v29, s[48:51], s12 offen offset:1024 sc1
    s_waitcnt lgkmcnt(0)
    s_barrier
    ds_read2_b64 v[52:55], v18 offset1:2
    ds_read2_b64 v[32:35], v17 offset1:2
    s_waitcnt lgkmcnt(0)
    v_add_f32 v52, v52, v53
    v_add_f32 v56, v54, v55
    v_add_f32 v32, v32, v33
    v_add_f32 v33, v34, v35
L_rzb:
    s_waitcnt vmcnt(0)
    v_xor_b32 v12, s39, v80
    v_bitop3_b32 v12, v81, s39, v12 bitop3:0xbe
    v_bitop3_b32 v12, v84, s39, v12 bitop3:0xbe
    v_bitop3_b32 v12, v85, s39, v12 bitop3:0xbe
    v_bitop3_b32 v12, v86, s39, v12 bitop3:0xbe
    v_bitop3_b32 v12, v87, s39, v12 bitop3:0xbe
    v_bitop3_b32 v12, v88, s39, v12 bitop3:0xbe
    v_bitop3_b32 v12, v89, s39, v12 bitop3:0xbe
    v_bitop3_b32 v12, v92, s39, v12 bitop3:0xbe
    v_bitop3_b32 v12, v93, s39, v12 bitop3:0xbe
    v_bitop3_b32 v12, v94, s39, v12 bitop3:0xbe
    v_bitop3_b32 v12, v95, s39, v12 bitop3:0xbe
    v_bitop3_b32 v12, v96, s39, v12 bitop3:0xbe
    v_bitop3_b32 v12, v97, s39, v12 bitop3:0xbe
    v_bitop3_b32 v12, v98, s39, v12 bitop3:0xbe
    v_bitop3_b32 v12, v99, s39, v12 bitop3:0xbe
    v_bitop3_b32 v12, v100, s39, v12 bitop3:0xbe
    v_bitop3_b32 v12, v101, s39, v12 bitop3:0xbe
    v_bitop3_b32 v12, v102, s39, v12 bitop3:0xbe
    v_bitop3_b32 v12, v103, s39, v12 bitop3:0xbe
    v_add_f32 v84, v84, v92
    v_add_f32 v86, v86, v94
    v_and_b32 v12, 0xff, v12
    v_cmp_ne_u32 vcc, 0, v12
    v_add_f32 v84, v52, v84
    v_add_f32 v86, v56, v86
    s_cbranch_vccnz L_rz
    v_mul_f32 v52, 0x39638e39, v84
    v_fmac_f32 v49, 0x3ae38e39, v86
    v_fma_f32 v49, -v52, v52, v49
    v_rsq_f32 v49, v49
    v_pk_add_f32 v[96:97], v[96:97], v[100:101]
    v_pk_add_f32 v[98:99], v[98:99], v[102:103]
    v_pk_add_f32 v[80:81], v[80:81], v[88:89]
    v_pk_add_f32 v[24:25], v[24:25], v[96:97]
    v_pk_add_f32 v[26:27], v[26:27], v[98:99]
    v_pk_add_f32 v[32:33], v[32:33], v[80:81]
    v_fma_f32 v32, -v52, v24, v32
    v_fma_f32 v33, -v52, v26, v33
    v_fma_f32 v32, v32, v49, v25
    v_fma_f32 v33, v33, v49, v27
    v_cvt_pk_bf16_f32 v33, v32, v33
    v_lshlrev_b32 v32, 16, v33
    v_and_b32 v33, 0xffff0000, v33
    v_mul_f32 v34, v32, v32
    v_mov_b32 v35, 0xc0135761
    v_fmac_f32 v35, 0xbdd2d3e8, v34
    v_mul_f32 v35, v35, v32
    v_exp_f32 v35, v35
    s_nop 0
    v_add_f32 v35, 1.0, v35
    v_rcp_f32 v35, v35
    s_nop 0
    v_mul_f32 v32, v32, v35
    v_cvt_pk_bf16_f32 v32, v32, v32
    v_and_b32 v32, 0xffff0000, v32
    v_mul_f32 v32, v32, v33
    s_nop 1
    v_mov_b32_dpp v33, v32 quad_perm:[1,0,3,2] row_mask:0xf bank_mask:0xf
    v_cvt_pk_bf16_f32 v112, v32, v33
    s_nop 1
    v_mov_b32_dpp v113, v112 row_ror:14 row_mask:0xf bank_mask:0xf
    v_mov_b32_dpp v114, v112 row_ror:12 row_mask:0xf bank_mask:0xf
    v_mov_b32_dpp v115, v112 row_ror:10 row_mask:0xf bank_mask:0xf
    s_nop 1
    v_mfma_f32_16x16x32_bf16 v[96:99], a[112:115], v[112:115], 0
    v_mfma_f32_16x16x32_bf16 v[64:67], v[112:115], a[80:83], 0
    v_mfma_f32_16x16x32_bf16 v[80:83], v[112:115], a[96:99], 0
    v_mfma_f32_16x16x32_bf16 v[68:71], v[112:115], a[84:87], 0
    v_and_or_b32 v96, v96, v6, s39
    v_mfma_f32_16x16x32_bf16 v[84:87], v[112:115], a[100:103], 0
    v_mfma_f32_16x16x32_bf16 v[72:75], v[112:115], a[88:91], 0
    v_cndmask_b32 v32, v64, v80, s[74:75]
    v_and_or_b32 v32, v32, v6, s39
    v_mfma_f32_16x16x32_bf16 v[88:91], v[112:115], a[104:107], 0
    v_mfma_f32_16x16x32_bf16 v[76:79], v[112:115], a[92:95], 0
    v_cndmask_b32 v33, v68, v84, s[74:75]
    v_mfma_f32_16x16x32_bf16 v[92:95], v[112:115], a[108:111], 0
    s_mov_b32 exec_lo, 0x10001
    s_mov_b32 exec_hi, 0x10001
    buffer_store_dwordx4 v[96:99], v23, s[48:51], s72 offen sc1
    s_mov_b32 exec_lo, 0xffff
    s_mov_b32 exec_hi, 0xffff
    v_cndmask_b32 v34, v72, v88, s[74:75]
    s_nop 1
    v_cndmask_b32 v35, v76, v92, s[74:75]
    buffer_store_dwordx4 v[32:35], v22, s[48:51], s72 offen sc1
    s_cmp_lt_u32 s11, 2
    s_cbranch_scc1 L_done
    s_mov_b64 exec, -1
    buffer_store_dword v132, v21, s[48:51], s5 offen offset:512 sc1
    buffer_store_dword v133, v15, s[48:51], s5 offen offset:768 sc1
    buffer_store_dwordx4 v[152:155], v31, s[48:51], s5 offen sc1
    s_branch L_done
L_cs:
    buffer_load_dwordx4 v[64:67], v8, s[48:51], s4 offen sc1
    buffer_load_dwordx4 v[68:71], v8, s[48:51], s5 offen sc1
    buffer_load_dwordx4 v[72:75], v8, s[48:51], s6 offen sc1
    s_add_u32 s96, s96, 1
    s_cmp_ge_u32 s96, 40000
    s_cbranch_scc1 L_done
    s_waitcnt vmcnt(0)
    s_branch L_csb
L_fz:
    v_accvgpr_write_b32 a0, 0
    v_accvgpr_write_b32 a1, 0
    v_accvgpr_write_b32 a2, 0
    v_accvgpr_write_b32 a3, 0
    v_accvgpr_write_b32 a4, 0
    v_accvgpr_write_b32 a5, 0
    v_accvgpr_write_b32 a6, 0
    v_accvgpr_write_b32 a7, 0
    v_accvgpr_write_b32 a8, 0
    v_accvgpr_write_b32 a9, 0
    v_accvgpr_write_b32 a10, 0
    v_accvgpr_write_b32 a11, 0
    v_accvgpr_write_b32 a12, 0
    v_accvgpr_write_b32 a13, 0
    v_accvgpr_write_b32 a14, 0
    v_accvgpr_write_b32 a15, 0
    s_branch L_fzb
L_rz:
    s_add_u32 s47, s47, 1
    s_cmp_lg_u32 s47, 24
    s_cbranch_scc1 L_rz2
    s_mov_b32 s12, s4
    s_cmp_lt_u32 s11, 2
    s_cbranch_scc1 L_rz2
    buffer_store_dword v132, v21, s[48:51], s5 offen offset:512 sc1
    buffer_store_dword v133, v15, s[48:51], s5 offen offset:768 sc1
    buffer_store_dwordx4 v[152:155], v31, s[48:51], s5 offen sc1
L_rz2:
    buffer_load_dwordx2 v[80:81], v28, s[48:51], s12 offen offset:512 sc1
    buffer_load_dwordx4 v[84:87], v8, s[48:51], s12 offen offset:768 sc1
    buffer_load_dwordx2 v[88:89], v28, s[48:51], s12 offen offset:1536 sc1
    buffer_load_dwordx4 v[92:95], v8, s[48:51], s12 offen offset:1792 sc1
    buffer_load_dwordx4 v[96:99], v29, s[48:51], s12 offen sc1
    buffer_load_dwordx4 v[100:103], v29, s[48:51], s12 offen offset:1024 sc1
    s_add_u32 s96, s96, 1
    s_cmp_ge_u32 s96, 40000
    s_cbranch_scc1 L_done
    s_branch L_rzb
L_done:
L_end:
    s_endpgm
.section .rodata,"a"
.p2align 6
.amdhsa_kernel adaLN_cond__compressed_kv_cla__geglu_ffn__decode_kernel
  .amdhsa_next_free_vgpr 512
  .amdhsa_next_free_sgpr 102
  .amdhsa_accum_offset 256
  .amdhsa_group_segment_fixed_size 0
  .amdhsa_kernarg_size 120
  .amdhsa_user_sgpr_count 2
  .amdhsa_user_sgpr_kernarg_segment_ptr 1
  .amdhsa_system_sgpr_workgroup_id_x 1
.end_amdhsa_kernel
```
